```python
import torch

def _softmax(x, axis=-1):
    return torch.softmax(x, dim=axis)
def _gelu(x):
    return torch.nn.functional.gelu(x, approximate="tanh")
def _silu(x):
    return torch.nn.functional.silu(x)
def _sigmoid(x):
    return torch.sigmoid(x)
def _layernorm(x, axis=-1, eps=1e-5):
    m = x.mean(dim=axis, keepdim=True)
    v = x.var(dim=axis, keepdim=True, unbiased=False)
    return (x - m) / torch.sqrt(v + eps)
def _scatter_add(tgt, idx, src, axis=0):
    return tgt.clone().index_add_(axis, idx, src)
def _segment_sum(src, seg, n):
    out = torch.zeros((n,) + src.shape[1:], dtype=src.dtype)
    return out.index_add_(0, seg, src)
def _pad(x, pw):
    flat = tuple(v for pair in reversed(pw) for v in pair)
    return torch.nn.functional.pad(x, flat)

kernel_name = 'interleave_layers__sliding_block_cached__glu_gated_glu__decode'

def setup_inputs():

    _w = (lambda a: (lambda t: t.to(torch.bfloat16) if t.is_floating_point() else t)(torch.as_tensor(a)))
    def _A_setup():
        B, Sq, D = 8, 1, 448
        Hq, Hkv, Sk, Dh = 16, 8, 4096, 256
        assert Hq % Hkv == 0, (Hq, Hkv)
        return {
            "x": _w((lambda *s: torch.randn(*s, dtype=torch.bfloat16) * 0.05)(B, Sq, D)),
            "k_cache": _w((lambda *s: torch.randn(*s, dtype=torch.bfloat16) * 1.6)(B, Hkv, Sk, Dh)),
            "v_cache": _w((lambda *s: torch.randn(*s, dtype=torch.bfloat16) * 1.6)(B, Hkv, Sk, Dh)),
            "wq": _w((lambda *s: torch.randn(*s, dtype=torch.bfloat16) * 1.6)(D, Hq * Dh) * (D ** -0.5)),
            "wo": _w((lambda *s: torch.randn(*s, dtype=torch.bfloat16) * 1.6)(Hq * Dh, D) * ((Hq * Dh) ** -0.5)),
        }
    _A_in = _A_setup()

    def _B_setup():
        B, S, D, F = 8, 1, 448, 1792
        return {
            "x": _w((lambda *s: torch.randn(*s, dtype=torch.bfloat16) * 0.05)(B, S, D)),
            "w_gate": _w((lambda *s: torch.randn(*s, dtype=torch.bfloat16) * 0.05)(D, F)),
            "w_up": _w((lambda *s: torch.randn(*s, dtype=torch.bfloat16) * 0.05)(D, F)),
            "w_down": _w((lambda *s: torch.randn(*s, dtype=torch.bfloat16) * 0.05)(F, D)),
        }
    _B_in = _B_setup()

    return {
        "A_x": _A_in["x"],
        "A_k_cache": _A_in["k_cache"],
        "A_v_cache": _A_in["v_cache"],
        "A_wq": _A_in["wq"],
        "A_wo": _A_in["wo"],
        "B_x": _B_in["x"],
        "B_w_gate": _B_in["w_gate"],
        "B_w_up": _B_in["w_up"],
        "B_w_down": _B_in["w_down"],
    }

def reference(A_x, A_k_cache, A_v_cache, A_wq, A_wo, B_x, B_w_gate, B_w_up, B_w_down):
    def _A_ref(x, k_cache, v_cache, wq, wo):
        B, Sq, D = x.shape
        Hq, Dh = 16, 256
        Hkv, Sk = k_cache.shape[1], k_cache.shape[2]
        W = min(4096, max(256, Sk // 4))
        rep = Hq // Hkv
        q = (lambda x, *d: x.permute(*d))((x @ wq).reshape(B, Sq, Hq, Dh), 0, 2, 1, 3)
        k = (lambda x, n, axis: torch.repeat_interleave(x, n, dim=axis))(k_cache[:, :, Sk - W:, :], rep, axis=1)
        v = (lambda x, n, axis: torch.repeat_interleave(x, n, dim=axis))(v_cache[:, :, Sk - W:, :], rep, axis=1)
        scores = torch.einsum("bhqd,bhkd->bhqk", q, k) * (Dh ** -0.5)
        p = _softmax(scores, axis=-1)
        o = torch.einsum("bhqk,bhkd->bhqd", p, v)
        return (lambda x, *d: x.permute(*d))(o, 0, 2, 1, 3).reshape(B, Sq, Hq * Dh) @ wo

    def _B_ref(x, w_gate, w_up, w_down):
        g = torch.einsum("bsd,df->bsf", x, w_gate)
        u = torch.einsum("bsd,df->bsf", x, w_up)
        h = _sigmoid(g) * u
        return torch.einsum("bsf,fd->bsd", h, w_down)

    x = A_x
    x = x + _A_ref(_layernorm(x, axis=-1), A_k_cache, A_v_cache, A_wq, A_wo)
    x = x + _B_ref(_layernorm(x, axis=-1), B_w_gate, B_w_up, B_w_down)
    x = x + _A_ref(_layernorm(x, axis=-1), A_k_cache, A_v_cache, A_wq, A_wo)
    x = x + _B_ref(_layernorm(x, axis=-1), B_w_gate, B_w_up, B_w_down)
    return x
```

```asm
; @launch grid=(256,1,1) block=(512,1,1) lds=160000
.amdgcn_target "amdgcn-amd-amdhsa--gfx950"
.text
.globl interleave_layers__sliding_block_cached__glu_gated_glu__decode_kernel
.p2align 8
.type interleave_layers__sliding_block_cached__glu_gated_glu__decode_kernel,@function
interleave_layers__sliding_block_cached__glu_gated_glu__decode_kernel:
    s_cmp_ge_u32 s2, 256
    s_cbranch_scc1 L_end
    s_load_dwordx16 s[56:71], s[0:1], 0
    s_load_dwordx8 s[72:79], s[0:1], 64
    v_lshrrev_b32 v1, 6, v0
    v_and_b32 v0, 63, v0
    v_readfirstlane_b32 s98, v1
    v_lshrrev_b32 v1, 4, v0
    v_and_b32 v2, 15, v0
    s_and_b32 s96, s2, 7
    s_lshr_b32 s97, s2, 3
    v_lshrrev_b32 v19, 3, v0
    v_lshlrev_b32 v19, 13, v19
    v_and_b32 v20, 7, v0
    v_lshl_add_u32 v19, v20, 4, v19
    s_and_b32 s6, s97, 7
    s_lshl_b32 s6, s6, 7
    s_lshl_b32 s7, s96, 10
    s_add_u32 s6, s6, s7
    s_and_b32 s4, s98, 3
    s_lshl_b32 s4, s4, 5
    v_xor_b32 v19, s4, v19
    s_lshl_b32 s82, s98, 16
    s_add_u32 s82, s82, s6
    s_lshl_b32 s83, s98, 10
    s_add_u32 s83, s83, 4096
    s_lshr_b32 s3, s97, 2
    s_lshl_b32 s3, s3, 3
    s_add_u32 s3, s3, s96
    s_lshl_b32 s3, s3, 21
    s_and_b32 s4, s97, 3
    s_lshl_b32 s4, s4, 15
    s_add_u32 s3, s3, s4
    s_lshl_b32 s4, s98, 12
    s_add_u32 s3, s3, s4
    s_add_u32 s6, s3, 1572864
    s_lshl_b32 s7, s98, 13
    s_add_u32 s7, s7, 61440
    v_xor_b32 v38, v2, v1
    v_lshlrev_b32 v38, 4, v38
    v_lshl_add_u32 v40, v1, 9, v38
    v_xor_b32 v41, 64, v40
    v_xor_b32 v42, 128, v40
    v_xor_b32 v43, 192, v40
    v_lshrrev_b32 v24, 2, v2
    v_lshlrev_b32 v24, 5, v24
    v_and_b32 v25, 1, v2
    v_lshl_add_u32 v24, v25, 4, v24
    v_and_b32 v25, 1, v1
    v_lshl_add_u32 v24, v25, 3, v24
    v_bfe_u32 v25, v2, 1, 1
    v_mul_u32_u24 v25, 896, v25
    v_add_u32 v24, v24, v25
    s_lshl_b32 s3, s98, 7
    v_add_u32 v24, s3, v24
    s_mov_b32 s10, 0x120000
    s_mov_b32 s46, 0x1c00
    s_mov_b32 s47, 0x00020000
    s_mov_b32 s14, 0x8000000
    s_mov_b32 s15, 0x00020000
    s_mov_b32 s26, 0x380000
    s_mov_b32 s27, 0x00020000
    s_lshr_b32 s3, s97, 3
    s_mul_i32 s3, s3, 1792
    s_waitcnt lgkmcnt(0)
    s_mov_b64 s[24:25], s[62:63]
    s_mov_b64 s[44:45], s[56:57]
    s_mov_b64 s[12:13], s[58:59]
    s_mov_b64 s[40:41], s[72:73]
    s_mov_b64 s[52:53], s[76:77]
    s_load_dword s11, s[78:79], s10
    s_mov_b32 s72, s6
    s_mov_b32 s77, s7
    buffer_load_dwordx2 v[28:29], v24, s[44:47], s3 offen
    s_mov_b32 m0, s83
    s_add_u32 s83, s83, 8192
    buffer_load_dwordx4 v19, s[24:27], s82 offen lds
    s_add_u32 s82, s82, 524288
    s_add_u32 s4, s77, 0
    s_mov_b32 m0, s4
    s_add_u32 s3, s72, 0
    buffer_load_dwordx4 v40, s[12:15], s3 offen nt lds
    s_mov_b32 m0, s83
    s_add_u32 s83, s83, 8192
    buffer_load_dwordx4 v19, s[24:27], s82 offen lds
    s_add_u32 s82, s82, 524288
    s_add_u32 s4, s77, 1024
    s_mov_b32 m0, s4
    s_add_u32 s3, s72, 2048
    buffer_load_dwordx4 v41, s[12:15], s3 offen nt lds
    s_mov_b32 m0, s83
    s_add_u32 s83, s83, 8192
    buffer_load_dwordx4 v19, s[24:27], s82 offen lds
    s_add_u32 s82, s82, 524288
    s_add_u32 s4, s77, 2048
    s_mov_b32 m0, s4
    s_add_u32 s3, s72, 131072
    buffer_load_dwordx4 v42, s[12:15], s3 offen nt lds
    s_cmp_ge_u32 s98, 4
    s_cbranch_scc1 L_halfB
    v_mov_b32 v51, 159872
    v_mov_b32 v52, 0
    v_mov_b32 v53, 0
    ds_write_b64 v51, v[52:53]
    ds_write_b32 v51, v52 offset:8
    s_mov_b64 s[16:17], s[60:61]
    s_mov_b64 s[28:29], s[64:65]
    s_mov_b64 s[48:49], s[74:75]
    s_mov_b64 s[20:21], s[78:79]
    s_mov_b32 s18, 0x8000000
    s_mov_b32 s19, 0x00020000
    s_mov_b32 s30, 0x380000
    s_mov_b32 s31, 0x00020000
    s_mov_b32 s34, 0x188000
    s_mov_b32 s35, 0x00020000
    s_mov_b32 s42, 0x188000
    s_mov_b32 s43, 0x00020000
    s_mov_b32 s50, 0x1c00
    s_mov_b32 s51, 0x00020000
    s_mov_b32 s54, 0x100
    s_mov_b32 s55, 0x00020000
    s_mov_b32 s22, 0x20000000
    s_mov_b32 s23, 0x00020000
    s_cmp_ge_u32 s98, 4
    s_cselect_b64 s[32:33], s[70:71], s[68:69]
    v_lshl_add_u32 v44, v2, 8, v38
    v_add_u32 v44, s77, v44
    v_xor_b32 v45, 64, v44
    v_xor_b32 v46, 128, v44
    v_xor_b32 v47, 192, v44
    v_lshlrev_b32 v37, 4, v2
    v_and_b32 v20, 1, v1
    v_lshl_add_u32 v37, v20, 11, v37
    v_lshrrev_b32 v20, 1, v1
    v_lshl_add_u32 v37, v20, 17, v37
    s_add_u32 s76, s72, 0x40000
    v_lshrrev_b32 v20, 2, v0
    v_and_b32 v21, 3, v0
    v_mul_u32_u24 v38, 3584, v20
    v_lshrrev_b32 v22, 5, v0
    v_xor_b32 v22, v21, v22
    s_and_b32 s4, s98, 1
    s_lshl_b32 s4, s4, 1
    v_xor_b32 v22, s4, v22
    v_lshl_add_u32 v38, v22, 4, v38
    v_mul_u32_u24 v49, 896, v20
    v_lshl_add_u32 v49, v21, 4, v49
    v_lshrrev_b32 v20, 1, v0
    v_and_b32 v21, 1, v0
    v_mul_u32_u24 v36, 896, v20
    v_lshl_add_u32 v36, v21, 4, v36
    s_and_b32 s90, s97, 7
    s_xor_b32 s90, s90, 4
    s_cmp_eq_u32 s96, 1
    s_cselect_b32 s3, 8, 9
    s_sub_u32 s3, s3, s96
    s_add_u32 s3, s3, s90
    s_and_b32 s4, s3, 7
    s_lshl_b32 s4, s90, 1
    s_bfe_u32 s91, s97, 0x10003
    s_add_u32 s91, s91, s4
    s_sub_u32 s3, s3, 1
    s_and_b32 s3, s3, 7
    s_lshl_b32 s3, s3, 2
    s_lshr_b32 s92, s97, 3
    s_add_u32 s92, s92, s3
    s_cmp_lt_u32 s90, 7
    s_cselect_b64 s[36:37], -1, 0
    s_cmp_lt_u32 s91, 14
    s_cselect_b64 s[38:39], -1, 0
    s_cmp_lt_u32 s92, 28
    s_cselect_b64 s[94:95], -1, 0
    s_cmp_eq_u32 s98, 7
    s_cselect_b64 s[94:95], 0, s[94:95]
    s_mul_i32 s84, s96, 448
    s_min_u32 s4, s90, 6
    s_lshl_b32 s4, s4, 6
    s_add_u32 s84, s84, s4
    s_and_b32 s4, s98, 3
    s_lshl_b32 s85, s4, 10
    s_mul_i32 s4, s4, 57344
    s_add_u32 s84, s84, s4
    s_lshr_b32 s4, s98, 2
    s_mul_i32 s4, s4, 28672
    s_add_u32 s85, s85, s4
    s_add_u32 s85, s85, 4096
    s_mul_i32 s5, s98, 4
    s_mul_i32 s4, s98, 4
    s_sub_u32 s4, s4, 0
    s_cmp_ge_u32 s98, 4
    s_cselect_b32 s5, s4, s5
    s_lshl_b32 s3, s96, 5
    s_add_u32 s3, s3, s5
    s_mul_i32 s86, s3, 14336
    s_min_u32 s4, s91, 13
    s_lshl_b32 s4, s4, 6
    s_add_u32 s86, s86, s4
    s_lshl_b32 s87, s5, 10
    s_add_u32 s87, s87, 126976
    s_mul_i32 s88, s96, 200704
    s_min_u32 s4, s92, 27
    s_lshl_b32 s4, s4, 5
    s_add_u32 s88, s88, s4
    s_min_u32 s4, s98, 6
    s_mul_i32 s4, s4, 28672
    s_add_u32 s88, s88, s4
    s_add_u32 s89, s77, 4096
    s_waitcnt lgkmcnt(0)
    s_barrier
    v_mov_b32 v52, 1
    s_add_u32 s73, s11, 1
    s_mov_b32 s75, 0
    s_mov_b32 s74, 0
    s_mov_b32 s99, 0
    s_mov_b32 s100, 0
    s_mov_b32 s101, 30000
    s_mov_b32 s80, 0x00030003
    s_mov_b32 s81, 0x00030003
    v_and_b32 v20, 1, v2
    v_lshlrev_b32 v20, 4, v20
    v_mov_b32 v21, 0x3f80
    v_lshlrev_b32 v21, v20, v21
    v_bfe_u32 v20, v2, 1, 2
    v_cmp_eq_u32 vcc, 0, v20
    s_nop 1
    v_cndmask_b32 v12, 0, v21, vcc
    v_cmp_eq_u32 vcc, 1, v20
    s_nop 1
    v_cndmask_b32 v13, 0, v21, vcc
    v_cmp_eq_u32 vcc, 2, v20
    s_nop 1
    v_cndmask_b32 v14, 0, v21, vcc
    v_cmp_eq_u32 vcc, 3, v20
    s_nop 1
    v_cndmask_b32 v15, 0, v21, vcc
    v_and_b32 v27, 2, v2
    v_and_b32 v26, 1, v1
    v_add_lshl_u32 v27, v27, v26, 3
    s_lshl_b32 s3, s98, 5
    v_add_u32 v27, s3, v27
    v_mov_b32 v26, 0x3f803f80
    s_mov_b32 s8, 0x00050005
    s_mov_b32 s9, 0
    s_setprio 1
    s_mov_b32 m0, s83
    s_add_u32 s83, s83, 8192
    s_waitcnt vmcnt(5)
    buffer_load_dwordx4 v19, s[24:27], s82 offen lds
    s_add_u32 s82, s82, 524288
    s_add_u32 s4, s77, 3072
    s_mov_b32 m0, s4
    s_add_u32 s3, s72, 133120
    s_waitcnt vmcnt(5)
    buffer_load_dwordx4 v43, s[12:15], s3 offen nt lds
    s_mov_b32 m0, s83
    s_add_u32 s83, s83, 8192
    s_waitcnt vmcnt(5)
    buffer_load_dwordx4 v19, s[24:27], s82 offen lds
    s_add_u32 s82, s82, 524288
    s_add_u32 s4, s77, 4096
    s_mov_b32 m0, s4
    s_add_u32 s3, s72, 256
    s_waitcnt vmcnt(5)
    buffer_load_dwordx4 v40, s[12:15], s3 offen nt lds
    s_mov_b32 m0, s83
    s_add_u32 s83, s83, 8192
    s_waitcnt vmcnt(5)
    buffer_load_dwordx4 v19, s[24:27], s82 offen lds
    s_add_u32 s82, s82, 524288
    s_add_u32 s4, s77, 5120
    s_mov_b32 m0, s4
    s_add_u32 s3, s72, 2304
    s_waitcnt vmcnt(5)
    buffer_load_dwordx4 v41, s[12:15], s3 offen nt lds
    s_mov_b32 m0, s83
    s_add_u32 s83, s83, 8192
    s_waitcnt vmcnt(5)
    buffer_load_dwordx4 v19, s[24:27], s82 offen lds
    s_add_u32 s82, s82, 524288
    s_add_u32 s4, s77, 6144
    s_mov_b32 m0, s4
    s_add_u32 s3, s72, 131328
    s_waitcnt vmcnt(5)
    buffer_load_dwordx4 v42, s[12:15], s3 offen nt lds
    s_add_u32 s4, s77, 7168
    s_mov_b32 m0, s4
    s_add_u32 s3, s72, 133376
    s_waitcnt vmcnt(5)
    buffer_load_dwordx4 v43, s[12:15], s3 offen nt lds
    s_waitcnt vmcnt(15)
    ds_write_b64 v24, v[28:29] offset:0
    v_dot2_f32_bf16 v16, v28, v26, 0
    v_dot2_f32_bf16 v17, v28, v28, 0
    v_dot2_f32_bf16 v16, v29, v26, v16
    v_dot2_f32_bf16 v17, v29, v29, v17
    s_nop 2
    v_add_f32_dpp v16, v16, v16 quad_perm:[1,0,3,2] row_mask:0xf bank_mask:0xf
    v_add_f32_dpp v17, v17, v17 quad_perm:[1,0,3,2] row_mask:0xf bank_mask:0xf
    s_nop 0
    v_add_f32_dpp v16, v16, v16 row_ror:4 row_mask:0xf bank_mask:0xf
    v_add_f32_dpp v17, v17, v17 row_ror:4 row_mask:0xf bank_mask:0xf
    s_nop 0
    v_add_f32_dpp v16, v16, v16 row_ror:8 row_mask:0xf bank_mask:0xf
    v_add_f32_dpp v17, v17, v17 row_ror:8 row_mask:0xf bank_mask:0xf
    s_mov_b64 exec, s[8:9]
    ds_write_b64 v27, v[16:17] offset:3584
    s_mov_b64 exec, -1
    v_lshlrev_b32 v4, 16, v28
    v_and_b32 v5, 0xffff0000, v28
    v_lshlrev_b32 v6, 16, v29
    v_and_b32 v7, 0xffff0000, v29
    s_waitcnt vmcnt(5)
    buffer_load_dwordx4 v[72:75], v37, s[16:19], s72 offen offset:0 nt
    s_waitcnt vmcnt(5)
    buffer_load_dwordx4 v[76:79], v37, s[16:19], s72 offen offset:512 nt
    s_waitcnt vmcnt(4)
    s_waitcnt lgkmcnt(0)
    s_mov_b64 exec, 1
    ds_add_u32 v51, v52 offset:0
    s_mov_b64 exec, -1
    s_waitcnt vmcnt(9)
    ds_read_b128 a[0:3], v44 offset:0
    ds_read_b128 a[4:7], v45 offset:0
    ds_read_b128 a[8:11], v46 offset:0
    ds_read_b128 a[12:15], v47 offset:0
    s_waitcnt lgkmcnt(0)
    s_add_u32 s4, s77, 0
    s_mov_b32 m0, s4
    s_add_u32 s3, s72, 262144
    s_waitcnt vmcnt(5)
    buffer_load_dwordx4 v40, s[12:15], s3 offen nt lds
    s_add_u32 s4, s77, 1024
    s_mov_b32 m0, s4
    s_add_u32 s3, s72, 264192
    s_waitcnt vmcnt(5)
    buffer_load_dwordx4 v41, s[12:15], s3 offen nt lds
    s_add_u32 s4, s77, 2048
    s_mov_b32 m0, s4
    s_add_u32 s3, s72, 393216
    s_waitcnt vmcnt(5)
    buffer_load_dwordx4 v42, s[12:15], s3 offen nt lds
    s_add_u32 s4, s77, 3072
    s_mov_b32 m0, s4
    s_add_u32 s3, s72, 395264
    s_waitcnt vmcnt(5)
    buffer_load_dwordx4 v43, s[12:15], s3 offen nt lds
    s_waitcnt vmcnt(6)
    ds_read_b128 a[16:19], v44 offset:4096
    ds_read_b128 a[20:23], v45 offset:4096
    ds_read_b128 a[24:27], v46 offset:4096
    ds_read_b128 a[28:31], v47 offset:4096
    s_waitcnt lgkmcnt(0)
    s_add_u32 s4, s77, 4096
    s_mov_b32 m0, s4
    s_add_u32 s3, s72, 262400
    buffer_load_dwordx4 v40, s[12:15], s3 offen nt lds
    s_add_u32 s4, s77, 5120
    s_mov_b32 m0, s4
    s_add_u32 s3, s72, 264448
    buffer_load_dwordx4 v41, s[12:15], s3 offen nt lds
    s_add_u32 s4, s77, 6144
    s_mov_b32 m0, s4
    s_add_u32 s3, s72, 393472
    buffer_load_dwordx4 v42, s[12:15], s3 offen nt lds
    s_add_u32 s4, s77, 7168
    s_mov_b32 m0, s4
    s_add_u32 s3, s72, 395520
    buffer_load_dwordx4 v43, s[12:15], s3 offen nt lds
    buffer_load_dwordx4 v[80:83], v37, s[16:19], s72 offen offset:1024 nt
    buffer_load_dwordx4 v[84:87], v37, s[16:19], s72 offen offset:1536 nt
    v_lshrrev_b32 v20, 2, v2
    v_lshl_add_u32 v20, v1, 3, v20
    v_lshlrev_b32 v20, 7, v20
    v_and_b32 v21, 3, v2
    v_lshl_add_u32 v20, v21, 3, v20
    v_xor_b32 v21, s98, v1
    v_lshl_add_u32 v20, v21, 5, v20
Lw_1:
    ds_read_b32 v53, v51 offset:0
    s_waitcnt lgkmcnt(0)
    v_readfirstlane_b32 s3, v53
    s_cmp_ge_u32 s3, 8
    s_cbranch_scc1 Lw_1_ok
    s_sub_u32 s101, s101, 1
    s_cbranch_scc1 Lw_1_to
    s_sleep 1
    s_branch Lw_1
Lw_1_to:
    s_mov_b32 s101, 0
Lw_1_ok:
    ds_read_b64_tr_b16 a[64:65], v20 offset:4096
    ds_read_b64_tr_b16 a[66:67], v20 offset:4608
    ds_read_b64_tr_b16 a[68:69], v20 offset:8192
    ds_read_b64_tr_b16 a[70:71], v20 offset:8704
    ds_read_b64_tr_b16 a[72:73], v20 offset:12288
    ds_read_b64_tr_b16 a[74:75], v20 offset:12800
    ds_read_b64_tr_b16 a[76:77], v20 offset:16384
    ds_read_b64_tr_b16 a[78:79], v20 offset:16896
    ds_read_b64_tr_b16 a[80:81], v20 offset:20480
    ds_read_b64_tr_b16 a[82:83], v20 offset:20992
    ds_read_b64_tr_b16 a[84:85], v20 offset:24576
    ds_read_b64_tr_b16 a[86:87], v20 offset:25088
    ds_read_b64_tr_b16 a[88:89], v20 offset:28672
    ds_read_b64_tr_b16 a[90:91], v20 offset:29184
    ds_read_b64_tr_b16 a[92:93], v20 offset:32768
    ds_read_b64_tr_b16 a[94:95], v20 offset:33280
    ds_read_b64_tr_b16 a[96:97], v20 offset:36864
    ds_read_b64_tr_b16 a[98:99], v20 offset:37376
    ds_read_b64_tr_b16 a[100:101], v20 offset:40960
    ds_read_b64_tr_b16 a[102:103], v20 offset:41472
    ds_read_b64_tr_b16 a[104:105], v20 offset:45056
    ds_read_b64_tr_b16 a[106:107], v20 offset:45568
    ds_read_b64_tr_b16 a[108:109], v20 offset:49152
    ds_read_b64_tr_b16 a[110:111], v20 offset:49664
    ds_read_b64_tr_b16 a[112:113], v20 offset:53248
    ds_read_b64_tr_b16 a[114:115], v20 offset:53760
    ds_read_b64_tr_b16 a[116:117], v20 offset:57344
    ds_read_b64_tr_b16 a[118:119], v20 offset:57856
    v_mov_b32 v32, 0x3f803f80
    v_mov_b32 v33, 0x3f803f80
    v_mov_b32 v34, 0x3f803f80
    v_mov_b32 v35, 0x3f803f80
    s_waitcnt lgkmcnt(0)
    s_mov_b64 exec, 1
    ds_add_u32 v51, v52 offset:4
    s_mov_b64 exec, -1
    s_nop 0
    v_mfma_f32_16x16x32_bf16 v[8:11], a[64:67], v[32:35], 0
    v_mfma_f32_16x16x32_bf16 v[8:11], a[68:71], v[32:35], v[8:11]
    v_mfma_f32_16x16x32_bf16 v[8:11], a[72:75], v[32:35], v[8:11]
    v_mfma_f32_16x16x32_bf16 v[8:11], a[76:79], v[32:35], v[8:11]
    v_mfma_f32_16x16x32_bf16 v[8:11], a[80:83], v[32:35], v[8:11]
    v_mfma_f32_16x16x32_bf16 v[8:11], a[84:87], v[32:35], v[8:11]
    v_mfma_f32_16x16x32_bf16 v[8:11], a[88:91], v[32:35], v[8:11]
    v_mfma_f32_16x16x32_bf16 v[8:11], a[92:95], v[32:35], v[8:11]
    v_mfma_f32_16x16x32_bf16 v[8:11], a[96:99], v[32:35], v[8:11]
    v_mfma_f32_16x16x32_bf16 v[8:11], a[100:103], v[32:35], v[8:11]
    v_mfma_f32_16x16x32_bf16 v[8:11], a[104:107], v[32:35], v[8:11]
    v_mfma_f32_16x16x32_bf16 v[8:11], a[108:111], v[32:35], v[8:11]
    v_mfma_f32_16x16x32_bf16 v[8:11], a[112:115], v[32:35], v[8:11]
    v_mfma_f32_16x16x32_bf16 v[8:11], a[116:119], v[32:35], v[8:11]
    v_and_b32 v30, 1, v2
    v_mul_u32_u24 v30, 896, v30
    v_lshl_add_u32 v30, v1, 4, v30
    v_lshlrev_b32 v31, 4, v2
    v_and_b32 v22, 1, v2
    v_lshlrev_b32 v22, 11, v22
    v_lshrrev_b32 v23, 1, v1
    v_lshl_add_u32 v22, v23, 9, v22
    v_and_b32 v23, 1, v1
    v_lshl_add_u32 v22, v23, 4, v22
    s_lshl_b32 s5, s96, 14
    s_add_u32 s5, s5, 0x100000
    s_lshr_b32 s3, s97, 3
    s_lshl_b32 s3, s3, 12
    s_add_u32 s5, s5, s3
    s_bfe_u32 s3, s97, 0x20000
    s_lshl_b32 s3, s3, 7
    s_add_u32 s5, s5, s3
    s_bfe_u32 s3, s97, 0x10002
    s_lshl_b32 s3, s3, 5
    s_add_u32 s5, s5, s3
    s_bfe_u32 s3, s98, 0x10001
    s_lshl_b32 s3, s3, 6
    s_add_u32 s5, s5, s3
    s_and_b32 s3, s98, 1
    s_lshl_b32 s3, s3, 10
    s_add_u32 s5, s5, s3
    s_waitcnt lgkmcnt(0)
    ds_read_b128 v[104:107], v30 offset:0
    ds_read_b128 v[108:111], v30 offset:64
    ds_read_b128 v[32:35], v31 offset:3584
    ds_read_b128 v[112:115], v30 offset:128
    ds_read_b128 v[116:119], v30 offset:192
    ds_read_b128 v[120:123], v30 offset:256
    ds_read_b128 v[124:127], v30 offset:320
    ds_read_b128 v[128:131], v30 offset:384
    ds_read_b128 v[132:135], v30 offset:448
    s_waitcnt lgkmcnt(8)
    v_mfma_f32_16x16x32_bf16 v[16:19], a[64:67], v[104:107], 0
    ds_read_b128 v[104:107], v30 offset:512
    s_waitcnt lgkmcnt(8)
    v_mfma_f32_16x16x32_bf16 v[16:19], a[68:71], v[108:111], v[16:19]
    ds_read_b128 v[108:111], v30 offset:576
    s_waitcnt lgkmcnt(7)
    v_mfma_f32_16x16x32_bf16 v[16:19], a[72:75], v[112:115], v[16:19]
    ds_read_b128 v[112:115], v30 offset:640
    v_add_f32 v20, v32, v34
    v_add_f32 v21, v33, v35
    s_waitcnt lgkmcnt(7)
    v_mfma_f32_16x16x32_bf16 v[16:19], a[76:79], v[116:119], v[16:19]
    ds_read_b128 v[116:119], v30 offset:704
    v_add_f32_dpp v20, v20, v20 quad_perm:[2,3,0,1] row_mask:0xf bank_mask:0xf
    v_add_f32_dpp v21, v21, v21 quad_perm:[2,3,0,1] row_mask:0xf bank_mask:0xf
    s_waitcnt lgkmcnt(7)
    v_mfma_f32_16x16x32_bf16 v[16:19], a[80:83], v[120:123], v[16:19]
    ds_read_b128 v[120:123], v30 offset:768
    v_add_f32_dpp v20, v20, v20 row_ror:4 row_mask:0xf bank_mask:0xf
    v_add_f32_dpp v21, v21, v21 row_ror:4 row_mask:0xf bank_mask:0xf
    s_waitcnt lgkmcnt(7)
    v_mfma_f32_16x16x32_bf16 v[16:19], a[84:87], v[124:127], v[16:19]
    ds_read_b128 v[124:127], v30 offset:832
    v_add_f32_dpp v20, v20, v20 row_ror:8 row_mask:0xf bank_mask:0xf
    v_add_f32_dpp v21, v21, v21 row_ror:8 row_mask:0xf bank_mask:0xf
    s_waitcnt lgkmcnt(7)
    v_mfma_f32_16x16x32_bf16 v[16:19], a[88:91], v[128:131], v[16:19]
    v_mul_f32 v20, 0x3b124925, v20
    v_mul_f32 v21, 0x3b124925, v21
    s_waitcnt lgkmcnt(6)
    v_mfma_f32_16x16x32_bf16 v[16:19], a[92:95], v[132:135], v[16:19]
    v_fma_f32 v21, -v20, v20, v21
    v_max_f32 v21, 0, v21
    s_waitcnt lgkmcnt(5)
    v_mfma_f32_16x16x32_bf16 v[16:19], a[96:99], v[104:107], v[16:19]
    v_add_f32 v21, 0x3727c5ac, v21
    v_rsq_f32 v21, v21
    s_waitcnt lgkmcnt(4)
    v_mfma_f32_16x16x32_bf16 v[16:19], a[100:103], v[108:111], v[16:19]
    v_mul_f32 v32, v20, v8
    v_mul_f32 v33, v20, v9
    s_waitcnt lgkmcnt(3)
    v_mfma_f32_16x16x32_bf16 v[16:19], a[104:107], v[112:115], v[16:19]
    v_mul_f32 v34, v20, v10
    v_mul_f32 v35, v20, v11
    s_waitcnt lgkmcnt(2)
    v_mfma_f32_16x16x32_bf16 v[16:19], a[108:111], v[116:119], v[16:19]
    v_mul_f32 v32, v21, v32
    v_mul_f32 v33, v21, v33
    s_waitcnt lgkmcnt(1)
    v_mfma_f32_16x16x32_bf16 v[16:19], a[112:115], v[120:123], v[16:19]
    v_mul_f32 v34, v21, v34
    v_mul_f32 v35, v21, v35
    s_waitcnt lgkmcnt(0)
    v_mfma_f32_16x16x32_bf16 v[16:19], a[116:119], v[124:127], v[16:19]
    s_nop 7
    v_fma_f32 v16, v21, v16, -v32
    v_fma_f32 v17, v21, v17, -v33
    v_fma_f32 v18, v21, v18, -v34
    v_fma_f32 v19, v21, v19, -v35
    v_cvt_pk_bf16_f32 v16, v16, v17
    v_cvt_pk_bf16_f32 v18, v18, v19
    v_mov_b32 v17, s73
    v_mov_b32 v19, s73
    s_mov_b64 exec, s[80:81]
    buffer_store_dwordx4 v[16:19], v22, s[20:23], s5 offen sc1
    s_mov_b64 exec, -1
    s_setprio 0
    s_waitcnt vmcnt(5)
    buffer_load_dwordx4 v[88:91], v37, s[16:19], s76 offen offset:0 nt
    s_mov_b32 m0, s87
    s_add_u32 s87, s87, 1024
    s_mov_b64 exec, s[38:39]
    s_waitcnt vmcnt(5)
    buffer_load_dwordx4 v49, s[28:31], s86 offen lds
    s_mov_b64 exec, -1
    s_add_u32 s86, s86, 14336
    s_waitcnt vmcnt(5)
    buffer_load_dwordx4 v[92:95], v37, s[16:19], s76 offen offset:512 nt
    s_mov_b32 m0, s87
    s_add_u32 s87, s87, 1024
    s_mov_b64 exec, s[38:39]
    s_waitcnt vmcnt(5)
    buffer_load_dwordx4 v49, s[28:31], s86 offen lds
    s_mov_b64 exec, -1
    s_add_u32 s86, s86, 14336
    s_waitcnt vmcnt(5)
    buffer_load_dwordx4 v[96:99], v37, s[16:19], s76 offen offset:1024 nt
    s_mov_b32 m0, s87
    s_add_u32 s87, s87, 1024
    s_mov_b64 exec, s[38:39]
    s_waitcnt vmcnt(5)
    buffer_load_dwordx4 v49, s[28:31], s86 offen lds
    s_mov_b64 exec, -1
    s_add_u32 s86, s86, 14336
    s_waitcnt vmcnt(5)
    buffer_load_dwordx4 v[100:103], v37, s[16:19], s76 offen offset:1536 nt
    s_mov_b32 m0, s87
    s_add_u32 s87, s87, 1024
    s_mov_b64 exec, s[38:39]
    s_waitcnt vmcnt(5)
    buffer_load_dwordx4 v49, s[28:31], s86 offen lds
    s_mov_b64 exec, -1
    s_add_u32 s86, s86, 14336
    s_waitcnt vmcnt(5)
    buffer_load_dwordx4 v[104:107], v37, s[16:19], s72 offen offset:256 nt
    s_waitcnt vmcnt(5)
    buffer_load_dwordx4 v[108:111], v37, s[16:19], s72 offen offset:768 nt
    v_lshlrev_b32 v39, 5, v0
    s_lshl_b32 s5, s96, 14
    s_add_u32 s5, s5, 0x100000
    s_lshr_b32 s3, s97, 2
    s_lshl_b32 s3, s3, 11
    s_add_u32 s5, s5, s3
    s_mov_b32 s4, 0x3db8aa3b
    buffer_load_dwordx4 v[24:27], v39, s[20:23], s5 offen sc1
    buffer_load_dwordx4 v[28:31], v39, s[20:23], s5 offen offset:16 sc1
    s_waitcnt vmcnt(18)
    ds_read_b128 a[32:35], v44 offset:0
    ds_read_b128 a[36:39], v45 offset:0
    ds_read_b128 a[40:43], v46 offset:0
    ds_read_b128 a[44:47], v47 offset:0
    s_waitcnt lgkmcnt(0)
    s_waitcnt vmcnt(14)
    ds_read_b128 a[48:51], v44 offset:4096
    ds_read_b128 a[52:55], v45 offset:4096
    ds_read_b128 a[56:59], v46 offset:4096
    ds_read_b128 a[60:63], v47 offset:4096
    s_waitcnt lgkmcnt(0)
    s_waitcnt vmcnt(5)
    buffer_load_dwordx4 v[112:115], v37, s[16:19], s72 offen offset:1280 nt
    s_waitcnt vmcnt(5)
    buffer_load_dwordx4 v[116:119], v37, s[16:19], s72 offen offset:1792 nt
    buffer_load_dwordx4 v[120:123], v37, s[16:19], s76 offen offset:256 nt
    buffer_load_dwordx4 v[124:127], v37, s[16:19], s76 offen offset:768 nt
    buffer_load_dwordx4 v[128:131], v37, s[16:19], s76 offen offset:1280 nt
    buffer_load_dwordx4 v[132:135], v37, s[16:19], s76 offen offset:1792 nt
Lw_2:
    ds_read_b32 v53, v51 offset:4
    s_waitcnt lgkmcnt(0)
    v_readfirstlane_b32 s3, v53
    s_cmp_ge_u32 s3, 4
    s_cbranch_scc1 Lw_2_ok
    s_sub_u32 s101, s101, 1
    s_cbranch_scc1 Lw_2_to
    s_sleep 1
    s_branch Lw_2
Lw_2_to:
    s_mov_b32 s101, 0
Lw_2_ok:
    s_waitcnt vmcnt(6)
Lq0_3:
    v_xor_b32 v16, s73, v25
    v_xor_b32 v17, s73, v27
    v_xor_b32 v18, s73, v29
    v_xor_b32 v19, s73, v31
    v_or3_b32 v16, v16, v17, v18
    v_or_b32 v16, v16, v19
    v_cmp_ne_u32 vcc, 0, v16
    s_cbranch_vccz Lq0_3_ok
    s_sub_u32 s101, s101, 1
    s_cbranch_scc1 Lq0_3_to
    s_mov_b64 exec, vcc
    buffer_load_dwordx4 v[24:27], v39, s[20:23], s5 offen sc1
    buffer_load_dwordx4 v[28:31], v39, s[20:23], s5 offen offset:16 sc1
    s_mov_b64 exec, -1
    s_waitcnt vmcnt(0)
    s_branch Lq0_3
Lq0_3_to:
    s_mov_b32 s101, 0
Lq0_3_ok:
    v_mov_b32 v16, v24
    v_mov_b32 v17, v26
    v_mov_b32 v18, v28
    v_mov_b32 v19, v30
    s_mov_b32 s4, 0x3db8aa3b
    s_nop 0
    v_mfma_f32_16x16x32_bf16 v[20:23], a[0:3], v[16:19], 0
    v_mov_b32_dpp v32, v16 row_ror:14 row_mask:0xf bank_mask:0xf
    v_mov_b32_dpp v33, v17 row_ror:14 row_mask:0xf bank_mask:0xf
    v_mov_b32_dpp v34, v18 row_ror:14 row_mask:0xf bank_mask:0xf
    v_mov_b32_dpp v35, v19 row_ror:14 row_mask:0xf bank_mask:0xf
    v_mfma_f32_16x16x32_bf16 v[24:27], a[32:35], v[16:19], 0
    s_nop 0
    v_mfma_f32_16x16x32_bf16 v[20:23], a[4:7], v[32:35], v[20:23]
    v_mov_b32_dpp v28, v16 row_ror:12 row_mask:0xf bank_mask:0xf
    v_mov_b32_dpp v29, v17 row_ror:12 row_mask:0xf bank_mask:0xf
    v_mov_b32_dpp v30, v18 row_ror:12 row_mask:0xf bank_mask:0xf
    v_mov_b32_dpp v31, v19 row_ror:12 row_mask:0xf bank_mask:0xf
    v_mfma_f32_16x16x32_bf16 v[24:27], a[36:39], v[32:35], v[24:27]
    s_nop 0
    v_mfma_f32_16x16x32_bf16 v[20:23], a[8:11], v[28:31], v[20:23]
    v_mov_b32_dpp v32, v16 row_ror:10 row_mask:0xf bank_mask:0xf
    v_mov_b32_dpp v33, v17 row_ror:10 row_mask:0xf bank_mask:0xf
    v_mov_b32_dpp v34, v18 row_ror:10 row_mask:0xf bank_mask:0xf
    v_mov_b32_dpp v35, v19 row_ror:10 row_mask:0xf bank_mask:0xf
    v_mfma_f32_16x16x32_bf16 v[24:27], a[40:43], v[28:31], v[24:27]
    s_nop 0
    v_mfma_f32_16x16x32_bf16 v[20:23], a[12:15], v[32:35], v[20:23]
    v_mov_b32_dpp v28, v16 row_ror:8 row_mask:0xf bank_mask:0xf
    v_mov_b32_dpp v29, v17 row_ror:8 row_mask:0xf bank_mask:0xf
    v_mov_b32_dpp v30, v18 row_ror:8 row_mask:0xf bank_mask:0xf
    v_mov_b32_dpp v31, v19 row_ror:8 row_mask:0xf bank_mask:0xf
    v_mfma_f32_16x16x32_bf16 v[24:27], a[44:47], v[32:35], v[24:27]
    s_nop 0
    v_mfma_f32_16x16x32_bf16 v[20:23], a[16:19], v[28:31], v[20:23]
    v_mov_b32_dpp v32, v16 row_ror:6 row_mask:0xf bank_mask:0xf
    v_mov_b32_dpp v33, v17 row_ror:6 row_mask:0xf bank_mask:0xf
    v_mov_b32_dpp v34, v18 row_ror:6 row_mask:0xf bank_mask:0xf
    v_mov_b32_dpp v35, v19 row_ror:6 row_mask:0xf bank_mask:0xf
    v_mfma_f32_16x16x32_bf16 v[24:27], a[48:51], v[28:31], v[24:27]
    s_nop 0
    v_mfma_f32_16x16x32_bf16 v[20:23], a[20:23], v[32:35], v[20:23]
    v_mov_b32_dpp v28, v16 row_ror:4 row_mask:0xf bank_mask:0xf
    v_mov_b32_dpp v29, v17 row_ror:4 row_mask:0xf bank_mask:0xf
    v_mov_b32_dpp v30, v18 row_ror:4 row_mask:0xf bank_mask:0xf
    v_mov_b32_dpp v31, v19 row_ror:4 row_mask:0xf bank_mask:0xf
    v_mfma_f32_16x16x32_bf16 v[24:27], a[52:55], v[32:35], v[24:27]
    s_nop 0
    v_mfma_f32_16x16x32_bf16 v[20:23], a[24:27], v[28:31], v[20:23]
    v_mov_b32_dpp v32, v16 row_ror:2 row_mask:0xf bank_mask:0xf
    v_mov_b32_dpp v33, v17 row_ror:2 row_mask:0xf bank_mask:0xf
    v_mov_b32_dpp v34, v18 row_ror:2 row_mask:0xf bank_mask:0xf
    v_mov_b32_dpp v35, v19 row_ror:2 row_mask:0xf bank_mask:0xf
    v_mfma_f32_16x16x32_bf16 v[24:27], a[56:59], v[28:31], v[24:27]
    s_nop 0
    v_mfma_f32_16x16x32_bf16 v[20:23], a[28:31], v[32:35], v[20:23]
    v_mfma_f32_16x16x32_bf16 v[24:27], a[60:63], v[32:35], v[24:27]
    v_mov_b32 v28, 0
    v_mov_b32 v29, 0
    v_mov_b32 v30, 0
    v_mov_b32 v31, 0
    s_nop 2
    v_max3_f32 v32, v20, v21, v22
    v_max3_f32 v33, v24, v25, v26
    v_max3_f32 v32, v32, v23, v27
    v_max_f32 v32, v32, v33
    v_mov_b32 v33, v32
    s_nop 1
    v_permlane16_swap_b32 v32, v33
    v_max_f32 v32, v32, v33
    v_mov_b32 v33, v32
    s_nop 1
    v_permlane32_swap_b32 v32, v33
    v_max_f32 v32, v32, v33
    v_mul_f32 v32, s4, v32
    v_fma_f32 v20, v20, s4, -v32
    v_fma_f32 v21, v21, s4, -v32
    v_fma_f32 v22, v22, s4, -v32
    v_fma_f32 v23, v23, s4, -v32
    v_fma_f32 v24, v24, s4, -v32
    v_fma_f32 v25, v25, s4, -v32
    v_fma_f32 v26, v26, s4, -v32
    v_fma_f32 v27, v27, s4, -v32
    v_exp_f32 v20, v20
    v_exp_f32 v21, v21
    v_exp_f32 v22, v22
    v_exp_f32 v23, v23
    v_exp_f32 v24, v24
    v_exp_f32 v25, v25
    v_exp_f32 v26, v26
    v_exp_f32 v27, v27
    s_mov_b64 exec, s[80:81]
    v_cvt_pk_bf16_f32 v28, v20, v21
    v_cvt_pk_bf16_f32 v29, v22, v23
    v_cvt_pk_bf16_f32 v30, v24, v25
    v_cvt_pk_bf16_f32 v31, v26, v27
    s_mov_b64 exec, -1
    v_add_f32 v33, v20, v21
    v_add_f32 v22, v22, v23
    v_add_f32 v24, v24, v25
    v_add_f32 v26, v26, v27
    v_add_f32 v33, v33, v22
    v_add_f32 v24, v24, v26
    v_add_f32 v33, v33, v24
    v_mov_b32 v34, v33
    s_nop 1
    v_permlane16_swap_b32 v33, v34
    v_add_f32 v33, v33, v34
    v_mov_b32 v34, v33
    s_nop 1
    v_permlane32_swap_b32 v33, v34
    v_add_f32 v33, v33, v34
    s_mov_b32 m0, s85
    s_add_u32 s85, s85, 4096
    s_mov_b64 exec, s[36:37]
    buffer_load_dwordx4 v38, s[32:35], s84 offen lds
    s_mov_b64 exec, -1
    s_add_u32 s84, s84, 229376
    s_mov_b32 m0, s85
    s_add_u32 s85, s85, 4096
    s_mov_b64 exec, s[36:37]
    buffer_load_dwordx4 v38, s[32:35], s84 offen lds
    s_mov_b64 exec, -1
    s_add_u32 s84, s84, 229376
    s_mov_b32 m0, s85
    s_add_u32 s85, s85, 4096
    s_mov_b64 exec, s[36:37]
    buffer_load_dwordx4 v38, s[32:35], s84 offen lds
    s_mov_b64 exec, -1
    s_add_u32 s84, s84, 229376
    s_waitcnt vmcnt(14)
    s_mov_b32 s6, 0x05040100
    s_mov_b32 s7, 0x07060302
    v_perm_b32 v40, v76, v72, s6
    v_perm_b32 v44, v76, v72, s7
    v_perm_b32 v48, v77, v73, s6
    v_perm_b32 v52, v77, v73, s7
    v_perm_b32 v56, v78, v74, s6
    v_perm_b32 v60, v78, v74, s7
    v_perm_b32 v64, v79, v75, s6
    v_perm_b32 v68, v79, v75, s7
    v_perm_b32 v41, v84, v80, s6
    v_perm_b32 v45, v84, v80, s7
    v_perm_b32 v49, v85, v81, s6
    v_perm_b32 v53, v85, v81, s7
    v_perm_b32 v57, v86, v82, s6
    v_perm_b32 v61, v86, v82, s7
    v_perm_b32 v65, v87, v83, s6
    v_perm_b32 v69, v87, v83, s7
    v_perm_b32 v42, v92, v88, s6
    v_perm_b32 v46, v92, v88, s7
    v_perm_b32 v50, v93, v89, s6
    v_perm_b32 v54, v93, v89, s7
    v_perm_b32 v58, v94, v90, s6
    v_perm_b32 v62, v94, v90, s7
    v_perm_b32 v66, v95, v91, s6
    v_perm_b32 v70, v95, v91, s7
    v_perm_b32 v43, v100, v96, s6
    v_perm_b32 v47, v100, v96, s7
    v_perm_b32 v51, v101, v97, s6
    v_perm_b32 v55, v101, v97, s7
    v_perm_b32 v59, v102, v98, s6
    v_perm_b32 v63, v102, v98, s7
    v_perm_b32 v67, v103, v99, s6
    v_perm_b32 v71, v103, v99, s7
    v_mfma_f32_16x16x32_bf16 v[16:19], v[40:43], v[28:31], 0
    v_mov_b32_dpp v24, v28 row_ror:2 row_mask:0xf bank_mask:0xf
    v_mov_b32_dpp v25, v29 row_ror:2 row_mask:0xf bank_mask:0xf
    v_mov_b32_dpp v26, v30 row_ror:2 row_mask:0xf bank_mask:0xf
    v_mov_b32_dpp v27, v31 row_ror:2 row_mask:0xf bank_mask:0xf
    s_nop 1
    v_mfma_f32_16x16x32_bf16 v[16:19], v[44:47], v[24:27], v[16:19]
    v_mov_b32_dpp v20, v28 row_ror:4 row_mask:0xf bank_mask:0xf
    v_mov_b32_dpp v21, v29 row_ror:4 row_mask:0xf bank_mask:0xf
    v_mov_b32_dpp v22, v30 row_ror:4 row_mask:0xf bank_mask:0xf
    v_mov_b32_dpp v23, v31 row_ror:4 row_mask:0xf bank_mask:0xf
    s_nop 1
    v_mfma_f32_16x16x32_bf16 v[16:19], v[48:51], v[20:23], v[16:19]
    v_mov_b32_dpp v24, v28 row_ror:6 row_mask:0xf bank_mask:0xf
    v_mov_b32_dpp v25, v29 row_ror:6 row_mask:0xf bank_mask:0xf
    v_mov_b32_dpp v26, v30 row_ror:6 row_mask:0xf bank_mask:0xf
    v_mov_b32_dpp v27, v31 row_ror:6 row_mask:0xf bank_mask:0xf
    s_nop 1
    v_mfma_f32_16x16x32_bf16 v[16:19], v[52:55], v[24:27], v[16:19]
    v_mov_b32_dpp v20, v28 row_ror:8 row_mask:0xf bank_mask:0xf
    v_mov_b32_dpp v21, v29 row_ror:8 row_mask:0xf bank_mask:0xf
    v_mov_b32_dpp v22, v30 row_ror:8 row_mask:0xf bank_mask:0xf
    v_mov_b32_dpp v23, v31 row_ror:8 row_mask:0xf bank_mask:0xf
    s_nop 1
    v_mfma_f32_16x16x32_bf16 v[16:19], v[56:59], v[20:23], v[16:19]
    v_mov_b32_dpp v24, v28 row_ror:10 row_mask:0xf bank_mask:0xf
    v_mov_b32_dpp v25, v29 row_ror:10 row_mask:0xf bank_mask:0xf
    v_mov_b32_dpp v26, v30 row_ror:10 row_mask:0xf bank_mask:0xf
    v_mov_b32_dpp v27, v31 row_ror:10 row_mask:0xf bank_mask:0xf
    s_nop 1
    v_mfma_f32_16x16x32_bf16 v[16:19], v[60:63], v[24:27], v[16:19]
    v_mov_b32_dpp v20, v28 row_ror:12 row_mask:0xf bank_mask:0xf
    v_mov_b32_dpp v21, v29 row_ror:12 row_mask:0xf bank_mask:0xf
    v_mov_b32_dpp v22, v30 row_ror:12 row_mask:0xf bank_mask:0xf
    v_mov_b32_dpp v23, v31 row_ror:12 row_mask:0xf bank_mask:0xf
    s_nop 1
    v_mfma_f32_16x16x32_bf16 v[16:19], v[64:67], v[20:23], v[16:19]
    v_mov_b32_dpp v24, v28 row_ror:14 row_mask:0xf bank_mask:0xf
    v_mov_b32_dpp v25, v29 row_ror:14 row_mask:0xf bank_mask:0xf
    v_mov_b32_dpp v26, v30 row_ror:14 row_mask:0xf bank_mask:0xf
    v_mov_b32_dpp v27, v31 row_ror:14 row_mask:0xf bank_mask:0xf
    s_nop 1
    v_mfma_f32_16x16x32_bf16 v[16:19], v[68:71], v[24:27], v[16:19]
    s_mov_b32 m0, s85
    s_add_u32 s85, s85, 4096
    s_mov_b64 exec, s[36:37]
    buffer_load_dwordx4 v38, s[32:35], s84 offen lds
    s_mov_b64 exec, -1
    s_add_u32 s84, s84, 229376
    s_mov_b32 m0, s85
    s_add_u32 s85, s85, 4096
    s_mov_b64 exec, s[36:37]
    buffer_load_dwordx4 v38, s[32:35], s84 offen lds
    s_mov_b64 exec, -1
    s_add_u32 s84, s84, 229376
    s_mov_b32 m0, s85
    s_add_u32 s85, s85, 4096
    s_mov_b64 exec, s[36:37]
    buffer_load_dwordx4 v38, s[32:35], s84 offen lds
    s_mov_b64 exec, -1
    s_add_u32 s84, s84, 229376
    s_mov_b32 m0, s85
    s_add_u32 s85, s85, 4096
    s_mov_b64 exec, s[36:37]
    buffer_load_dwordx4 v38, s[32:35], s84 offen lds
    s_mov_b64 exec, -1
    s_add_u32 s84, s84, 229376
    s_mov_b32 m0, s89
    s_add_u32 s89, s89, 1024
    s_mov_b64 exec, s[94:95]
    buffer_load_dwordx4 v36, s[40:43], s88 offen lds
    s_mov_b64 exec, -1
    s_add_u32 s88, s88, 0
    s_waitcnt vmcnt(16)
    v_perm_b32 v72, v108, v104, s6
    v_perm_b32 v76, v108, v104, s7
    v_perm_b32 v80, v109, v105, s6
    v_perm_b32 v84, v109, v105, s7
    v_perm_b32 v88, v110, v106, s6
    v_perm_b32 v92, v110, v106, s7
    v_perm_b32 v96, v111, v107, s6
    v_perm_b32 v100, v111, v107, s7
    s_waitcnt vmcnt(12)
    v_perm_b32 v73, v116, v112, s6
    v_perm_b32 v77, v116, v112, s7
    v_perm_b32 v81, v117, v113, s6
    v_perm_b32 v85, v117, v113, s7
    v_perm_b32 v89, v118, v114, s6
    v_perm_b32 v93, v118, v114, s7
    v_perm_b32 v97, v119, v115, s6
    v_perm_b32 v101, v119, v115, s7
    s_waitcnt vmcnt(10)
    v_perm_b32 v74, v124, v120, s6
    v_perm_b32 v78, v124, v120, s7
    v_perm_b32 v82, v125, v121, s6
    v_perm_b32 v86, v125, v121, s7
    v_perm_b32 v90, v126, v122, s6
    v_perm_b32 v94, v126, v122, s7
    v_perm_b32 v98, v127, v123, s6
    v_perm_b32 v102, v127, v123, s7
    s_waitcnt vmcnt(8)
    v_perm_b32 v75, v132, v128, s6
    v_perm_b32 v79, v132, v128, s7
    v_perm_b32 v83, v133, v129, s6
    v_perm_b32 v87, v133, v129, s7
    v_perm_b32 v91, v134, v130, s6
    v_perm_b32 v95, v134, v130, s7
    v_perm_b32 v99, v135, v131, s6
    v_perm_b32 v103, v135, v131, s7
    v_mfma_f32_16x16x32_bf16 v[36:39], v[72:75], v[28:31], 0
    v_mov_b32_dpp v24, v28 row_ror:2 row_mask:0xf bank_mask:0xf
    v_mov_b32_dpp v25, v29 row_ror:2 row_mask:0xf bank_mask:0xf
    v_mov_b32_dpp v26, v30 row_ror:2 row_mask:0xf bank_mask:0xf
    v_mov_b32_dpp v27, v31 row_ror:2 row_mask:0xf bank_mask:0xf
    s_nop 1
    v_mfma_f32_16x16x32_bf16 v[36:39], v[76:79], v[24:27], v[36:39]
    v_mov_b32_dpp v20, v28 row_ror:4 row_mask:0xf bank_mask:0xf
    v_mov_b32_dpp v21, v29 row_ror:4 row_mask:0xf bank_mask:0xf
    v_mov_b32_dpp v22, v30 row_ror:4 row_mask:0xf bank_mask:0xf
    v_mov_b32_dpp v23, v31 row_ror:4 row_mask:0xf bank_mask:0xf
    s_nop 1
    v_mfma_f32_16x16x32_bf16 v[36:39], v[80:83], v[20:23], v[36:39]
    v_mov_b32_dpp v24, v28 row_ror:6 row_mask:0xf bank_mask:0xf
    v_mov_b32_dpp v25, v29 row_ror:6 row_mask:0xf bank_mask:0xf
    v_mov_b32_dpp v26, v30 row_ror:6 row_mask:0xf bank_mask:0xf
    v_mov_b32_dpp v27, v31 row_ror:6 row_mask:0xf bank_mask:0xf
    s_nop 1
    v_mfma_f32_16x16x32_bf16 v[36:39], v[84:87], v[24:27], v[36:39]
    v_mov_b32_dpp v20, v28 row_ror:8 row_mask:0xf bank_mask:0xf
    v_mov_b32_dpp v21, v29 row_ror:8 row_mask:0xf bank_mask:0xf
    v_mov_b32_dpp v22, v30 row_ror:8 row_mask:0xf bank_mask:0xf
    v_mov_b32_dpp v23, v31 row_ror:8 row_mask:0xf bank_mask:0xf
    s_nop 1
    v_mfma_f32_16x16x32_bf16 v[36:39], v[88:91], v[20:23], v[36:39]
    v_mov_b32_dpp v24, v28 row_ror:10 row_mask:0xf bank_mask:0xf
    v_mov_b32_dpp v25, v29 row_ror:10 row_mask:0xf bank_mask:0xf
    v_mov_b32_dpp v26, v30 row_ror:10 row_mask:0xf bank_mask:0xf
    v_mov_b32_dpp v27, v31 row_ror:10 row_mask:0xf bank_mask:0xf
    s_nop 1
    v_mfma_f32_16x16x32_bf16 v[36:39], v[92:95], v[24:27], v[36:39]
    v_mov_b32_dpp v20, v28 row_ror:12 row_mask:0xf bank_mask:0xf
    v_mov_b32_dpp v21, v29 row_ror:12 row_mask:0xf bank_mask:0xf
    v_mov_b32_dpp v22, v30 row_ror:12 row_mask:0xf bank_mask:0xf
    v_mov_b32_dpp v23, v31 row_ror:12 row_mask:0xf bank_mask:0xf
    s_nop 1
    v_mfma_f32_16x16x32_bf16 v[36:39], v[96:99], v[20:23], v[36:39]
    v_mov_b32_dpp v24, v28 row_ror:14 row_mask:0xf bank_mask:0xf
    v_mov_b32_dpp v25, v29 row_ror:14 row_mask:0xf bank_mask:0xf
    v_mov_b32_dpp v26, v30 row_ror:14 row_mask:0xf bank_mask:0xf
    v_mov_b32_dpp v27, v31 row_ror:14 row_mask:0xf bank_mask:0xf
    s_nop 1
    v_mfma_f32_16x16x32_bf16 v[36:39], v[100:103], v[24:27], v[36:39]
    s_branch L_loop
L_halfB:
    v_mov_b32 v51, 159872
    v_mov_b32 v52, 0
    v_mov_b32 v53, 0
    ds_write_b64 v51, v[52:53]
    ds_write_b32 v51, v52 offset:8
    s_mov_b64 s[16:17], s[60:61]
    s_mov_b64 s[28:29], s[64:65]
    s_mov_b64 s[48:49], s[74:75]
    s_mov_b64 s[20:21], s[78:79]
    s_mov_b32 s18, 0x8000000
    s_mov_b32 s19, 0x00020000
    s_mov_b32 s30, 0x380000
    s_mov_b32 s31, 0x00020000
    s_mov_b32 s34, 0x188000
    s_mov_b32 s35, 0x00020000
    s_mov_b32 s42, 0x188000
    s_mov_b32 s43, 0x00020000
    s_mov_b32 s50, 0x1c00
    s_mov_b32 s51, 0x00020000
    s_mov_b32 s54, 0x100
    s_mov_b32 s55, 0x00020000
    s_mov_b32 s22, 0x20000000
    s_mov_b32 s23, 0x00020000
    s_cmp_ge_u32 s98, 4
    s_cselect_b64 s[32:33], s[70:71], s[68:69]
    v_lshl_add_u32 v44, v2, 8, v38
    v_add_u32 v44, s77, v44
    v_xor_b32 v45, 64, v44
    v_xor_b32 v46, 128, v44
    v_xor_b32 v47, 192, v44
    v_lshlrev_b32 v37, 4, v2
    v_and_b32 v20, 1, v1
    v_lshl_add_u32 v37, v20, 11, v37
    v_lshrrev_b32 v20, 1, v1
    v_lshl_add_u32 v37, v20, 17, v37
    s_add_u32 s76, s72, 0x40000
    v_lshrrev_b32 v20, 2, v0
    v_and_b32 v21, 3, v0
    v_mul_u32_u24 v38, 3584, v20
    v_lshrrev_b32 v22, 5, v0
    v_xor_b32 v22, v21, v22
    s_and_b32 s4, s98, 1
    s_lshl_b32 s4, s4, 1
    v_xor_b32 v22, s4, v22
    v_lshl_add_u32 v38, v22, 4, v38
    v_mul_u32_u24 v49, 896, v20
    v_lshl_add_u32 v49, v21, 4, v49
    v_lshrrev_b32 v20, 1, v0
    v_and_b32 v21, 1, v0
    v_mul_u32_u24 v36, 896, v20
    v_lshl_add_u32 v36, v21, 4, v36
    s_and_b32 s90, s97, 7
    s_xor_b32 s90, s90, 4
    s_cmp_eq_u32 s96, 1
    s_cselect_b32 s3, 8, 9
    s_sub_u32 s3, s3, s96
    s_add_u32 s3, s3, s90
    s_and_b32 s4, s3, 7
    s_lshl_b32 s4, s90, 1
    s_bfe_u32 s91, s97, 0x10003
    s_add_u32 s91, s91, s4
    s_sub_u32 s3, s3, 1
    s_and_b32 s3, s3, 7
    s_lshl_b32 s3, s3, 2
    s_lshr_b32 s92, s97, 3
    s_add_u32 s92, s92, s3
    s_cmp_lt_u32 s90, 7
    s_cselect_b64 s[36:37], -1, 0
    s_cmp_lt_u32 s91, 14
    s_cselect_b64 s[38:39], -1, 0
    s_cmp_lt_u32 s92, 28
    s_cselect_b64 s[94:95], -1, 0
    s_cmp_eq_u32 s98, 7
    s_cselect_b64 s[94:95], 0, s[94:95]
    s_mul_i32 s84, s96, 448
    s_min_u32 s4, s90, 6
    s_lshl_b32 s4, s4, 6
    s_add_u32 s84, s84, s4
    s_and_b32 s4, s98, 3
    s_lshl_b32 s85, s4, 10
    s_mul_i32 s4, s4, 57344
    s_add_u32 s84, s84, s4
    s_lshr_b32 s4, s98, 2
    s_mul_i32 s4, s4, 28672
    s_add_u32 s85, s85, s4
    s_add_u32 s85, s85, 4096
    s_mul_i32 s5, s98, 4
    s_mul_i32 s4, s98, 4
    s_sub_u32 s4, s4, 0
    s_cmp_ge_u32 s98, 4
    s_cselect_b32 s5, s4, s5
    s_lshl_b32 s3, s96, 5
    s_add_u32 s3, s3, s5
    s_mul_i32 s86, s3, 14336
    s_min_u32 s4, s91, 13
    s_lshl_b32 s4, s4, 6
    s_add_u32 s86, s86, s4
    s_lshl_b32 s87, s5, 10
    s_add_u32 s87, s87, 126976
    s_mul_i32 s88, s96, 200704
    s_min_u32 s4, s92, 27
    s_lshl_b32 s4, s4, 5
    s_add_u32 s88, s88, s4
    s_min_u32 s4, s98, 6
    s_mul_i32 s4, s4, 28672
    s_add_u32 s88, s88, s4
    s_add_u32 s89, s77, 4096
    s_waitcnt lgkmcnt(0)
    s_barrier
    v_mov_b32 v52, 1
    s_add_u32 s73, s11, 1
    s_mov_b32 s75, 0
    s_mov_b32 s74, 0
    s_mov_b32 s99, 0
    s_mov_b32 s100, 0
    s_mov_b32 s101, 30000
    s_mov_b32 s80, 0x00030003
    s_mov_b32 s81, 0x00030003
    v_and_b32 v20, 1, v2
    v_lshlrev_b32 v20, 4, v20
    v_mov_b32 v21, 0x3f80
    v_lshlrev_b32 v21, v20, v21
    v_bfe_u32 v20, v2, 1, 2
    v_cmp_eq_u32 vcc, 0, v20
    s_nop 1
    v_cndmask_b32 v12, 0, v21, vcc
    v_cmp_eq_u32 vcc, 1, v20
    s_nop 1
    v_cndmask_b32 v13, 0, v21, vcc
    v_cmp_eq_u32 vcc, 2, v20
    s_nop 1
    v_cndmask_b32 v14, 0, v21, vcc
    v_cmp_eq_u32 vcc, 3, v20
    s_nop 1
    v_cndmask_b32 v15, 0, v21, vcc
    v_and_b32 v27, 2, v2
    v_and_b32 v26, 1, v1
    v_add_lshl_u32 v27, v27, v26, 3
    s_lshl_b32 s3, s98, 5
    v_add_u32 v27, s3, v27
    v_mov_b32 v26, 0x3f803f80
    s_mov_b32 s8, 0x00050005
    s_mov_b32 s9, 0
    v_mov_b32 v32, -1
    v_mov_b32 v33, -1
    v_mov_b32 v34, -1
    v_mov_b32 v35, -1
    s_lshl_b32 s10, s96, 5
    s_add_u32 s10, s10, s97
    s_lshl_b32 s4, s10, 10
    s_add_u32 s5, s4, 0x78000
    v_lshlrev_b32 v20, 4, v0
    s_cmp_eq_u32 s98, 5
    s_cselect_b64 exec, -1, 0
    buffer_store_dwordx4 v[32:35], v20, s[20:23], s4 offen
    s_cmp_eq_u32 s98, 6
    s_cselect_b64 exec, -1, 0
    buffer_store_dwordx4 v[32:35], v20, s[20:23], s5 offen
    s_mov_b64 exec, -1
    s_lshl_b32 s4, s10, 8
    s_add_u32 s4, s4, 0xf0000
    v_add_u32 v21, s4, v20
    v_lshrrev_b32 v22, 3, v2
    v_mul_u32_u24 v22, 0x77f80, v22
    s_lshl_b32 s4, s10, 7
    s_add_u32 s4, s4, 0x5ff00
    v_add3_u32 v22, v22, s4, v20
    v_cmp_eq_u32 vcc, 1, v1
    s_nop 1
    v_cndmask_b32 v21, v21, v22, vcc
    v_mul_u32_u24 v22, 0x78000, v2
    s_lshl_b32 s4, s10, 4
    s_add_u32 s4, s4, 0x68000
    v_add_u32 v22, s4, v22
    v_cmp_eq_u32 vcc, 2, v1
    s_nop 1
    v_cndmask_b32 v21, v21, v22, vcc
    s_mov_b32 exec_hi, 3
    s_cmp_eq_u32 s98, 7
    s_cselect_b64 exec, exec, 0
    buffer_store_dwordx4 v[32:35], v21, s[20:23], 0 offen
    s_mov_b64 exec, -1
    v_and_b32 v20, 1, v1
    v_lshlrev_b32 v20, 16, v20
    v_lshrrev_b32 v21, 1, v1
    v_mul_u32_u24 v21, 0x78000, v21
    v_add_u32 v20, v20, v21
    v_lshl_add_u32 v20, v2, 4, v20
    s_lshl_b32 s4, s2, 8
    s_add_u32 s4, s4, 0x40000
    s_cmp_eq_u32 s98, 4
    s_cselect_b64 exec, -1, 0
    buffer_store_dwordx4 v[32:35], v20, s[20:23], s4 offen sc1
    s_mov_b64 exec, -1
    s_setprio 1
    s_mov_b32 m0, s83
    s_add_u32 s83, s83, 8192
    s_waitcnt vmcnt(9)
    buffer_load_dwordx4 v19, s[24:27], s82 offen lds
    s_add_u32 s82, s82, 524288
    s_add_u32 s4, s77, 3072
    s_mov_b32 m0, s4
    s_add_u32 s3, s72, 133120
    s_waitcnt vmcnt(9)
    buffer_load_dwordx4 v43, s[12:15], s3 offen nt lds
    s_mov_b32 m0, s83
    s_add_u32 s83, s83, 8192
    s_waitcnt vmcnt(9)
    buffer_load_dwordx4 v19, s[24:27], s82 offen lds
    s_add_u32 s82, s82, 524288
    s_add_u32 s4, s77, 4096
    s_mov_b32 m0, s4
    s_add_u32 s3, s72, 256
    s_waitcnt vmcnt(9)
    buffer_load_dwordx4 v40, s[12:15], s3 offen nt lds
    s_mov_b32 m0, s83
    s_add_u32 s83, s83, 8192
    s_waitcnt vmcnt(5)
    buffer_load_dwordx4 v19, s[24:27], s82 offen lds
    s_add_u32 s82, s82, 524288
    s_add_u32 s4, s77, 5120
    s_mov_b32 m0, s4
    s_add_u32 s3, s72, 2304
    s_waitcnt vmcnt(5)
    buffer_load_dwordx4 v41, s[12:15], s3 offen nt lds
    s_mov_b32 m0, s83
    s_add_u32 s83, s83, 8192
    s_waitcnt vmcnt(5)
    buffer_load_dwordx4 v19, s[24:27], s82 offen lds
    s_add_u32 s82, s82, 524288
    s_add_u32 s4, s77, 6144
    s_mov_b32 m0, s4
    s_add_u32 s3, s72, 131328
    s_waitcnt vmcnt(5)
    buffer_load_dwordx4 v42, s[12:15], s3 offen nt lds
    s_waitcnt vmcnt(8)
    s_mov_b64 exec, 1
    ds_add_u32 v51, v52 offset:8
    s_mov_b64 exec, -1
    s_add_u32 s4, s77, 7168
    s_mov_b32 m0, s4
    s_add_u32 s3, s72, 133376
    s_waitcnt vmcnt(5)
    buffer_load_dwordx4 v43, s[12:15], s3 offen nt lds
    s_waitcnt vmcnt(19)
    s_cmp_eq_u32 s98, 7
    s_cbranch_scc1 L_arr
    ds_write_b64 v24, v[28:29] offset:0
    v_dot2_f32_bf16 v16, v28, v26, 0
    v_dot2_f32_bf16 v17, v28, v28, 0
    v_dot2_f32_bf16 v16, v29, v26, v16
    v_dot2_f32_bf16 v17, v29, v29, v17
    s_nop 2
    v_add_f32_dpp v16, v16, v16 quad_perm:[1,0,3,2] row_mask:0xf bank_mask:0xf
    v_add_f32_dpp v17, v17, v17 quad_perm:[1,0,3,2] row_mask:0xf bank_mask:0xf
    s_nop 0
    v_add_f32_dpp v16, v16, v16 row_ror:4 row_mask:0xf bank_mask:0xf
    v_add_f32_dpp v17, v17, v17 row_ror:4 row_mask:0xf bank_mask:0xf
    s_nop 0
    v_add_f32_dpp v16, v16, v16 row_ror:8 row_mask:0xf bank_mask:0xf
    v_add_f32_dpp v17, v17, v17 row_ror:8 row_mask:0xf bank_mask:0xf
    s_mov_b64 exec, s[8:9]
    ds_write_b64 v27, v[16:17] offset:3584
    s_mov_b64 exec, -1
    v_lshlrev_b32 v4, 16, v28
    v_and_b32 v5, 0xffff0000, v28
    v_lshlrev_b32 v6, 16, v29
    v_and_b32 v7, 0xffff0000, v29
    s_branch L_noarr
L_arr:
    v_mov_b32 v20, 0
    v_and_b32 v21, 7, v0
    v_lshlrev_b32 v21, 2, v21
    ds_write_b32 v21, v20 offset:3808
    ds_write_b32 v21, v20 offset:4064
L_noarr:
    s_waitcnt vmcnt(5)
    buffer_load_dwordx4 v[72:75], v37, s[16:19], s72 offen offset:0 nt
    s_cmp_lg_u32 s98, 7
    s_cbranch_scc1 L_noarr2
Lw_4:
    ds_read_b32 v53, v51 offset:8
    s_waitcnt lgkmcnt(0)
    v_readfirstlane_b32 s3, v53
    s_cmp_ge_u32 s3, 4
    s_cbranch_scc1 Lw_4_ok
    s_sub_u32 s101, s101, 1
    s_cbranch_scc1 Lw_4_to
    s_sleep 1
    s_branch Lw_4
Lw_4_to:
    s_mov_b32 s101, 0
Lw_4_ok:
    s_getreg_b32 s3, hwreg(HW_REG_XCC_ID, 0, 4)
    s_and_b32 s3, s3, 7
    s_or_b32 s3, s3, 0x80
    v_mov_b32 v20, s3
    s_lshl_b32 s4, s96, 5
    s_add_u32 s4, s4, s97
    v_mov_b32 v21, s4
    s_mov_b64 exec, 1
    buffer_store_byte v20, v21, s[52:55], 0 offen sc1
    s_mov_b64 exec, -1
L_noarr2:
    s_waitcnt vmcnt(5)
    buffer_load_dwordx4 v[76:79], v37, s[16:19], s72 offen offset:512 nt
    s_waitcnt vmcnt(4)
    s_waitcnt lgkmcnt(0)
    s_mov_b64 exec, 1
    ds_add_u32 v51, v52 offset:0
    s_mov_b64 exec, -1
    s_waitcnt vmcnt(9)
    ds_read_b128 a[0:3], v44 offset:0
    ds_read_b128 a[4:7], v45 offset:0
    ds_read_b128 a[8:11], v46 offset:0
    ds_read_b128 a[12:15], v47 offset:0
    s_waitcnt lgkmcnt(0)
    s_add_u32 s4, s77, 0
    s_mov_b32 m0, s4
    s_add_u32 s3, s72, 262144
    s_waitcnt vmcnt(5)
    buffer_load_dwordx4 v40, s[12:15], s3 offen nt lds
    s_mov_b32 m0, s87
    s_add_u32 s87, s87, 1024
    s_mov_b64 exec, s[38:39]
    s_waitcnt vmcnt(5)
    buffer_load_dwordx4 v49, s[28:31], s86 offen lds
    s_mov_b64 exec, -1
    s_add_u32 s86, s86, 14336
    s_add_u32 s4, s77, 1024
    s_mov_b32 m0, s4
    s_add_u32 s3, s72, 264192
    s_waitcnt vmcnt(5)
    buffer_load_dwordx4 v41, s[12:15], s3 offen nt lds
    s_mov_b32 m0, s87
    s_add_u32 s87, s87, 1024
    s_mov_b64 exec, s[38:39]
    s_waitcnt vmcnt(5)
    buffer_load_dwordx4 v49, s[28:31], s86 offen lds
    s_mov_b64 exec, -1
    s_add_u32 s86, s86, 14336
    s_add_u32 s4, s77, 2048
    s_mov_b32 m0, s4
    s_add_u32 s3, s72, 393216
    s_waitcnt vmcnt(5)
    buffer_load_dwordx4 v42, s[12:15], s3 offen nt lds
    s_mov_b32 m0, s87
    s_add_u32 s87, s87, 1024
    s_mov_b64 exec, s[38:39]
    s_waitcnt vmcnt(5)
    buffer_load_dwordx4 v49, s[28:31], s86 offen lds
    s_mov_b64 exec, -1
    s_add_u32 s86, s86, 14336
    s_add_u32 s4, s77, 3072
    s_mov_b32 m0, s4
    s_add_u32 s3, s72, 395264
    s_waitcnt vmcnt(5)
    buffer_load_dwordx4 v43, s[12:15], s3 offen nt lds
    s_mov_b32 m0, s87
    s_add_u32 s87, s87, 1024
    s_mov_b64 exec, s[38:39]
    s_waitcnt vmcnt(5)
    buffer_load_dwordx4 v49, s[28:31], s86 offen lds
    s_mov_b64 exec, -1
    s_add_u32 s86, s86, 14336
    s_waitcnt vmcnt(10)
    ds_read_b128 a[16:19], v44 offset:4096
    ds_read_b128 a[20:23], v45 offset:4096
    ds_read_b128 a[24:27], v46 offset:4096
    ds_read_b128 a[28:31], v47 offset:4096
    s_waitcnt lgkmcnt(0)
    s_add_u32 s4, s77, 4096
    s_mov_b32 m0, s4
    s_add_u32 s3, s72, 262400
    s_waitcnt vmcnt(5)
    buffer_load_dwordx4 v40, s[12:15], s3 offen nt lds
    s_waitcnt vmcnt(5)
    buffer_load_dwordx4 v[80:83], v37, s[16:19], s72 offen offset:1024 nt
    s_add_u32 s4, s77, 5120
    s_mov_b32 m0, s4
    s_add_u32 s3, s72, 264448
    s_waitcnt vmcnt(5)
    buffer_load_dwordx4 v41, s[12:15], s3 offen nt lds
    s_waitcnt vmcnt(5)
    buffer_load_dwordx4 v[84:87], v37, s[16:19], s72 offen offset:1536 nt
    s_add_u32 s4, s77, 6144
    s_mov_b32 m0, s4
    s_add_u32 s3, s72, 393472
    s_waitcnt vmcnt(5)
    buffer_load_dwordx4 v42, s[12:15], s3 offen nt lds
    s_add_u32 s4, s77, 7168
    s_mov_b32 m0, s4
    s_add_u32 s3, s72, 395520
    s_waitcnt vmcnt(5)
    buffer_load_dwordx4 v43, s[12:15], s3 offen nt lds
    s_waitcnt vmcnt(5)
    buffer_load_dwordx4 v[88:91], v37, s[16:19], s76 offen offset:0 nt
    s_waitcnt vmcnt(5)
    buffer_load_dwordx4 v[92:95], v37, s[16:19], s76 offen offset:512 nt
    s_waitcnt vmcnt(5)
    buffer_load_dwordx4 v[96:99], v37, s[16:19], s76 offen offset:1024 nt
    s_waitcnt vmcnt(5)
    buffer_load_dwordx4 v[100:103], v37, s[16:19], s76 offen offset:1536 nt
    s_lshl_b32 s3, s96, 5
    s_add_u32 s3, s3, s97
    s_lshl_b32 s4, s3, 10
    v_lshlrev_b32 v20, 7, v0
    v_add_u32 v21, s4, v20
    s_lshl_b32 s4, s3, 7
    s_add_u32 s4, s4, 0x60000
    v_writelane_b32 v21, s4, 8
    s_lshl_b32 s4, s3, 4
    s_add_u32 s4, s4, 0x68000
    v_writelane_b32 v21, s4, 9
    s_cmp_eq_u32 s98, 6
    s_cselect_b64 exec, 0x3ff, 0
    s_waitcnt vmcnt(5)
    buffer_load_dword v35, v21, s[20:23], 0 offen sc1
    s_mov_b64 exec, -1
    s_waitcnt vmcnt(12)
    ds_read_b128 a[32:35], v44 offset:0
    ds_read_b128 a[36:39], v45 offset:0
    ds_read_b128 a[40:43], v46 offset:0
    ds_read_b128 a[44:47], v47 offset:0
    s_waitcnt lgkmcnt(0)
    s_waitcnt vmcnt(5)
    ds_read_b128 a[48:51], v44 offset:4096
    ds_read_b128 a[52:55], v45 offset:4096
    ds_read_b128 a[56:59], v46 offset:4096
    ds_read_b128 a[60:63], v47 offset:4096
    s_waitcnt lgkmcnt(0)
    s_waitcnt vmcnt(5)
    buffer_load_dwordx4 v[104:107], v37, s[16:19], s72 offen offset:256 nt
    s_waitcnt vmcnt(5)
    buffer_load_dwordx4 v[108:111], v37, s[16:19], s72 offen offset:768 nt
    s_waitcnt vmcnt(5)
    buffer_load_dwordx4 v[112:115], v37, s[16:19], s72 offen offset:1280 nt
    v_lshlrev_b32 v39, 5, v0
    s_lshl_b32 s5, s96, 14
    s_add_u32 s5, s5, 0x100000
    s_lshr_b32 s3, s97, 2
    s_lshl_b32 s3, s3, 11
    s_add_u32 s5, s5, s3
    s_mov_b32 s4, 0x3db8aa3b
    buffer_load_dwordx4 v[24:27], v39, s[20:23], s5 offen sc1
    buffer_load_dwordx4 v[28:31], v39, s[20:23], s5 offen offset:16 sc1
    v_lshlrev_b32 v55, 2, v0
    s_cmp_eq_u32 s98, 7
    s_cselect_b64 exec, -1, 0
    buffer_load_dword v54, v55, s[52:55], 0 offen sc1
    s_mov_b64 exec, -1
    s_waitcnt vmcnt(5)
    buffer_load_dwordx4 v[116:119], v37, s[16:19], s72 offen offset:1792 nt
    s_waitcnt vmcnt(5)
    buffer_load_dwordx4 v[120:123], v37, s[16:19], s76 offen offset:256 nt
    buffer_load_dwordx4 v[124:127], v37, s[16:19], s76 offen offset:768 nt
    buffer_load_dwordx4 v[128:131], v37, s[16:19], s76 offen offset:1280 nt
    buffer_load_dwordx4 v[132:135], v37, s[16:19], s76 offen offset:1792 nt
Lw_5:
    ds_read_b32 v53, v51 offset:4
    s_waitcnt lgkmcnt(0)
    v_readfirstlane_b32 s3, v53
    s_cmp_ge_u32 s3, 4
    s_cbranch_scc1 Lw_5_ok
    s_sub_u32 s101, s101, 1
    s_cbranch_scc1 Lw_5_to
    s_sleep 1
    s_branch Lw_5
Lw_5_to:
    s_mov_b32 s101, 0
Lw_5_ok:
    s_waitcnt vmcnt(6)
Lq0_6:
    v_xor_b32 v16, s73, v25
    v_xor_b32 v17, s73, v27
    v_xor_b32 v18, s73, v29
    v_xor_b32 v19, s73, v31
    v_or3_b32 v16, v16, v17, v18
    v_or_b32 v16, v16, v19
    v_cmp_ne_u32 vcc, 0, v16
    s_cbranch_vccz Lq0_6_ok
    s_sub_u32 s101, s101, 1
    s_cbranch_scc1 Lq0_6_to
    s_mov_b64 exec, vcc
    buffer_load_dwordx4 v[24:27], v39, s[20:23], s5 offen sc1
    buffer_load_dwordx4 v[28:31], v39, s[20:23], s5 offen offset:16 sc1
    s_mov_b64 exec, -1
    s_waitcnt vmcnt(0)
    s_branch Lq0_6
Lq0_6_to:
    s_mov_b32 s101, 0
Lq0_6_ok:
    v_mov_b32 v16, v24
    v_mov_b32 v17, v26
    v_mov_b32 v18, v28
    v_mov_b32 v19, v30
    s_mov_b32 s4, 0x3db8aa3b
    s_nop 0
    v_mfma_f32_16x16x32_bf16 v[20:23], a[0:3], v[16:19], 0
    v_mov_b32_dpp v32, v16 row_ror:14 row_mask:0xf bank_mask:0xf
    v_mov_b32_dpp v33, v17 row_ror:14 row_mask:0xf bank_mask:0xf
    v_mov_b32_dpp v34, v18 row_ror:14 row_mask:0xf bank_mask:0xf
    v_mov_b32_dpp v35, v19 row_ror:14 row_mask:0xf bank_mask:0xf
    v_mfma_f32_16x16x32_bf16 v[24:27], a[32:35], v[16:19], 0
    s_nop 0
    v_mfma_f32_16x16x32_bf16 v[20:23], a[4:7], v[32:35], v[20:23]
    v_mov_b32_dpp v28, v16 row_ror:12 row_mask:0xf bank_mask:0xf
    v_mov_b32_dpp v29, v17 row_ror:12 row_mask:0xf bank_mask:0xf
    v_mov_b32_dpp v30, v18 row_ror:12 row_mask:0xf bank_mask:0xf
    v_mov_b32_dpp v31, v19 row_ror:12 row_mask:0xf bank_mask:0xf
    v_mfma_f32_16x16x32_bf16 v[24:27], a[36:39], v[32:35], v[24:27]
    s_nop 0
    v_mfma_f32_16x16x32_bf16 v[20:23], a[8:11], v[28:31], v[20:23]
    v_mov_b32_dpp v32, v16 row_ror:10 row_mask:0xf bank_mask:0xf
    v_mov_b32_dpp v33, v17 row_ror:10 row_mask:0xf bank_mask:0xf
    v_mov_b32_dpp v34, v18 row_ror:10 row_mask:0xf bank_mask:0xf
    v_mov_b32_dpp v35, v19 row_ror:10 row_mask:0xf bank_mask:0xf
    v_mfma_f32_16x16x32_bf16 v[24:27], a[40:43], v[28:31], v[24:27]
    s_nop 0
    v_mfma_f32_16x16x32_bf16 v[20:23], a[12:15], v[32:35], v[20:23]
    v_mov_b32_dpp v28, v16 row_ror:8 row_mask:0xf bank_mask:0xf
    v_mov_b32_dpp v29, v17 row_ror:8 row_mask:0xf bank_mask:0xf
    v_mov_b32_dpp v30, v18 row_ror:8 row_mask:0xf bank_mask:0xf
    v_mov_b32_dpp v31, v19 row_ror:8 row_mask:0xf bank_mask:0xf
    v_mfma_f32_16x16x32_bf16 v[24:27], a[44:47], v[32:35], v[24:27]
    s_nop 0
    v_mfma_f32_16x16x32_bf16 v[20:23], a[16:19], v[28:31], v[20:23]
    v_mov_b32_dpp v32, v16 row_ror:6 row_mask:0xf bank_mask:0xf
    v_mov_b32_dpp v33, v17 row_ror:6 row_mask:0xf bank_mask:0xf
    v_mov_b32_dpp v34, v18 row_ror:6 row_mask:0xf bank_mask:0xf
    v_mov_b32_dpp v35, v19 row_ror:6 row_mask:0xf bank_mask:0xf
    v_mfma_f32_16x16x32_bf16 v[24:27], a[48:51], v[28:31], v[24:27]
    s_nop 0
    v_mfma_f32_16x16x32_bf16 v[20:23], a[20:23], v[32:35], v[20:23]
    v_mov_b32_dpp v28, v16 row_ror:4 row_mask:0xf bank_mask:0xf
    v_mov_b32_dpp v29, v17 row_ror:4 row_mask:0xf bank_mask:0xf
    v_mov_b32_dpp v30, v18 row_ror:4 row_mask:0xf bank_mask:0xf
    v_mov_b32_dpp v31, v19 row_ror:4 row_mask:0xf bank_mask:0xf
    v_mfma_f32_16x16x32_bf16 v[24:27], a[52:55], v[32:35], v[24:27]
    s_nop 0
    v_mfma_f32_16x16x32_bf16 v[20:23], a[24:27], v[28:31], v[20:23]
    v_mov_b32_dpp v32, v16 row_ror:2 row_mask:0xf bank_mask:0xf
    v_mov_b32_dpp v33, v17 row_ror:2 row_mask:0xf bank_mask:0xf
    v_mov_b32_dpp v34, v18 row_ror:2 row_mask:0xf bank_mask:0xf
    v_mov_b32_dpp v35, v19 row_ror:2 row_mask:0xf bank_mask:0xf
    v_mfma_f32_16x16x32_bf16 v[24:27], a[56:59], v[28:31], v[24:27]
    s_nop 0
    v_mfma_f32_16x16x32_bf16 v[20:23], a[28:31], v[32:35], v[20:23]
    v_mfma_f32_16x16x32_bf16 v[24:27], a[60:63], v[32:35], v[24:27]
    v_mov_b32 v28, 0
    v_mov_b32 v29, 0
    v_mov_b32 v30, 0
    v_mov_b32 v31, 0
    s_nop 2
    v_max3_f32 v32, v20, v21, v22
    v_max3_f32 v33, v24, v25, v26
    v_max3_f32 v32, v32, v23, v27
    v_max_f32 v32, v32, v33
    v_mov_b32 v33, v32
    s_nop 1
    v_permlane16_swap_b32 v32, v33
    v_max_f32 v32, v32, v33
    v_mov_b32 v33, v32
    s_nop 1
    v_permlane32_swap_b32 v32, v33
    v_max_f32 v32, v32, v33
    v_mul_f32 v32, s4, v32
    v_fma_f32 v20, v20, s4, -v32
    v_fma_f32 v21, v21, s4, -v32
    v_fma_f32 v22, v22, s4, -v32
    v_fma_f32 v23, v23, s4, -v32
    v_fma_f32 v24, v24, s4, -v32
    v_fma_f32 v25, v25, s4, -v32
    v_fma_f32 v26, v26, s4, -v32
    v_fma_f32 v27, v27, s4, -v32
    v_exp_f32 v20, v20
    v_exp_f32 v21, v21
    v_exp_f32 v22, v22
    v_exp_f32 v23, v23
    v_exp_f32 v24, v24
    v_exp_f32 v25, v25
    v_exp_f32 v26, v26
    v_exp_f32 v27, v27
    s_mov_b64 exec, s[80:81]
    v_cvt_pk_bf16_f32 v28, v20, v21
    v_cvt_pk_bf16_f32 v29, v22, v23
    v_cvt_pk_bf16_f32 v30, v24, v25
    v_cvt_pk_bf16_f32 v31, v26, v27
    s_mov_b64 exec, -1
    v_add_f32 v33, v20, v21
    v_add_f32 v22, v22, v23
    v_add_f32 v24, v24, v25
    v_add_f32 v26, v26, v27
    v_add_f32 v33, v33, v22
    v_add_f32 v24, v24, v26
    v_add_f32 v33, v33, v24
    v_mov_b32 v34, v33
    s_nop 1
    v_permlane16_swap_b32 v33, v34
    v_add_f32 v33, v33, v34
    v_mov_b32 v34, v33
    s_nop 1
    v_permlane32_swap_b32 v33, v34
    v_add_f32 v33, v33, v34
    s_cmp_lg_u32 s98, 7
    s_cbranch_scc1 L_nochkw
    s_waitcnt vmcnt(5)
Lchk_7:
    s_mov_b32 s3, 0x80808080
    v_and_b32 v20, s3, v54
    v_cmp_ne_u32 vcc, s3, v20
    s_cbranch_vccz Lchk_7_ok
    s_sub_u32 s101, s101, 1
    s_cbranch_scc1 Lchk_7_to
    s_sleep 16
    buffer_load_dword v54, v55, s[52:55], 0 offen sc1
    s_waitcnt vmcnt(0)
    s_branch Lchk_7
Lchk_7_to:
    s_mov_b32 s101, 0
Lchk_7_ok:
    s_getreg_b32 s3, hwreg(HW_REG_XCC_ID, 0, 4)
    s_and_b32 s3, s3, 7
    s_or_b32 s3, s3, 0x80
    s_mul_i32 s3, s3, 0x01010101
    v_cmp_eq_u32 vcc, s3, v54
    s_lshl_b32 s4, s96, 3
    s_lshr_b64 s[10:11], vcc, s4
    s_and_b32 s3, s10, 0xff
    s_cmp_eq_u32 s3, 0xff
    s_cselect_b32 s100, 1, 0
    s_cbranch_scc1 Lchk_7_f
    v_mov_b32 v24, -1
    v_mov_b32 v25, -1
    v_mov_b32 v26, -1
    v_mov_b32 v27, -1
    s_lshl_b32 s10, s96, 5
    s_add_u32 s10, s10, s97
    s_lshl_b32 s4, s10, 10
    s_add_u32 s5, s4, 0x78000
    v_lshlrev_b32 v20, 4, v0
    buffer_store_dwordx4 v[24:27], v20, s[20:23], s4 offen sc1
    buffer_store_dwordx4 v[24:27], v20, s[20:23], s5 offen sc1
    s_mov_b64 exec, -1
    s_lshl_b32 s4, s10, 8
    s_add_u32 s4, s4, 0xf0000
    v_add_u32 v21, s4, v20
    v_lshrrev_b32 v22, 3, v2
    v_mul_u32_u24 v22, 0x77f80, v22
    s_lshl_b32 s4, s10, 7
    s_add_u32 s4, s4, 0x5ff00
    v_add3_u32 v22, v22, s4, v20
    v_cmp_eq_u32 vcc, 1, v1
    s_nop 1
    v_cndmask_b32 v21, v21, v22, vcc
    v_mul_u32_u24 v22, 0x78000, v2
    s_lshl_b32 s4, s10, 4
    s_add_u32 s4, s4, 0x68000
    v_add_u32 v22, s4, v22
    v_cmp_eq_u32 vcc, 2, v1
    s_nop 1
    v_cndmask_b32 v21, v21, v22, vcc
    s_mov_b32 exec_hi, 3
    buffer_store_dwordx4 v[24:27], v21, s[20:23], 0 offen sc1
    s_mov_b64 exec, -1
    s_waitcnt vmcnt(0)
    s_getreg_b32 s3, hwreg(HW_REG_XCC_ID, 0, 4)
    s_and_b32 s3, s3, 7
    s_or_b32 s3, s3, 0xc0
    v_mov_b32 v20, s3
    s_lshl_b32 s4, s96, 5
    s_add_u32 s4, s4, s97
    v_mov_b32 v21, s4
    s_mov_b64 exec, 1
    buffer_store_byte v20, v21, s[52:55], 0 offen sc1
    s_mov_b64 exec, -1
Lchk_7_w:
    buffer_load_dword v54, v55, s[52:55], 0 offen sc1
    s_waitcnt vmcnt(0)
    s_mov_b32 s3, 0x40404040
    v_and_b32 v20, s3, v54
    v_cmp_eq_u32 vcc, s3, v20
    s_lshl_b32 s4, s96, 3
    s_lshr_b64 s[10:11], vcc, s4
    s_and_b32 s3, s10, 0xff
    s_cmp_eq_u32 s3, 0xff
    s_cbranch_scc1 Lchk_7_f
    s_sub_u32 s101, s101, 1
    s_cbranch_scc0 Lchk_7_w
    s_mov_b32 s101, 0
Lchk_7_f:
    v_mov_b32 v20, s100
    ds_write_b32 v51, v20 offset:12
L_nochkw:
    s_mov_b32 m0, s85
    s_add_u32 s85, s85, 4096
    s_mov_b64 exec, s[36:37]
    buffer_load_dwordx4 v38, s[32:35], s84 offen lds
    s_mov_b64 exec, -1
    s_add_u32 s84, s84, 229376
    s_mov_b32 m0, s85
    s_add_u32 s85, s85, 4096
    s_mov_b64 exec, s[36:37]
    buffer_load_dwordx4 v38, s[32:35], s84 offen lds
    s_mov_b64 exec, -1
    s_add_u32 s84, s84, 229376
    s_mov_b32 m0, s85
    s_add_u32 s85, s85, 4096
    s_mov_b64 exec, s[36:37]
    buffer_load_dwordx4 v38, s[32:35], s84 offen lds
    s_mov_b64 exec, -1
    s_add_u32 s84, s84, 229376
    s_waitcnt vmcnt(15)
    s_mov_b32 s6, 0x05040100
    s_mov_b32 s7, 0x07060302
    v_perm_b32 v40, v76, v72, s6
    v_perm_b32 v44, v76, v72, s7
    v_perm_b32 v48, v77, v73, s6
    v_perm_b32 v52, v77, v73, s7
    v_perm_b32 v56, v78, v74, s6
    v_perm_b32 v60, v78, v74, s7
    v_perm_b32 v64, v79, v75, s6
    v_perm_b32 v68, v79, v75, s7
    v_perm_b32 v41, v84, v80, s6
    v_perm_b32 v45, v84, v80, s7
    v_perm_b32 v49, v85, v81, s6
    v_perm_b32 v53, v85, v81, s7
    v_perm_b32 v57, v86, v82, s6
    v_perm_b32 v61, v86, v82, s7
    v_perm_b32 v65, v87, v83, s6
    v_perm_b32 v69, v87, v83, s7
    v_perm_b32 v42, v92, v88, s6
    v_perm_b32 v46, v92, v88, s7
    v_perm_b32 v50, v93, v89, s6
    v_perm_b32 v54, v93, v89, s7
    v_perm_b32 v58, v94, v90, s6
    v_perm_b32 v62, v94, v90, s7
    v_perm_b32 v66, v95, v91, s6
    v_perm_b32 v70, v95, v91, s7
    v_perm_b32 v43, v100, v96, s6
    v_perm_b32 v47, v100, v96, s7
    v_perm_b32 v51, v101, v97, s6
    v_perm_b32 v55, v101, v97, s7
    v_perm_b32 v59, v102, v98, s6
    v_perm_b32 v63, v102, v98, s7
    v_perm_b32 v67, v103, v99, s6
    v_perm_b32 v71, v103, v99, s7
    v_mfma_f32_16x16x32_bf16 v[16:19], v[40:43], v[28:31], 0
    v_mov_b32_dpp v24, v28 row_ror:2 row_mask:0xf bank_mask:0xf
    v_mov_b32_dpp v25, v29 row_ror:2 row_mask:0xf bank_mask:0xf
    v_mov_b32_dpp v26, v30 row_ror:2 row_mask:0xf bank_mask:0xf
    v_mov_b32_dpp v27, v31 row_ror:2 row_mask:0xf bank_mask:0xf
    s_nop 1
    v_mfma_f32_16x16x32_bf16 v[16:19], v[44:47], v[24:27], v[16:19]
    v_mov_b32_dpp v20, v28 row_ror:4 row_mask:0xf bank_mask:0xf
    v_mov_b32_dpp v21, v29 row_ror:4 row_mask:0xf bank_mask:0xf
    v_mov_b32_dpp v22, v30 row_ror:4 row_mask:0xf bank_mask:0xf
    v_mov_b32_dpp v23, v31 row_ror:4 row_mask:0xf bank_mask:0xf
    s_nop 1
    v_mfma_f32_16x16x32_bf16 v[16:19], v[48:51], v[20:23], v[16:19]
    v_mov_b32_dpp v24, v28 row_ror:6 row_mask:0xf bank_mask:0xf
    v_mov_b32_dpp v25, v29 row_ror:6 row_mask:0xf bank_mask:0xf
    v_mov_b32_dpp v26, v30 row_ror:6 row_mask:0xf bank_mask:0xf
    v_mov_b32_dpp v27, v31 row_ror:6 row_mask:0xf bank_mask:0xf
    s_nop 1
    v_mfma_f32_16x16x32_bf16 v[16:19], v[52:55], v[24:27], v[16:19]
    v_mov_b32_dpp v20, v28 row_ror:8 row_mask:0xf bank_mask:0xf
    v_mov_b32_dpp v21, v29 row_ror:8 row_mask:0xf bank_mask:0xf
    v_mov_b32_dpp v22, v30 row_ror:8 row_mask:0xf bank_mask:0xf
    v_mov_b32_dpp v23, v31 row_ror:8 row_mask:0xf bank_mask:0xf
    s_nop 1
    v_mfma_f32_16x16x32_bf16 v[16:19], v[56:59], v[20:23], v[16:19]
    v_mov_b32_dpp v24, v28 row_ror:10 row_mask:0xf bank_mask:0xf
    v_mov_b32_dpp v25, v29 row_ror:10 row_mask:0xf bank_mask:0xf
    v_mov_b32_dpp v26, v30 row_ror:10 row_mask:0xf bank_mask:0xf
    v_mov_b32_dpp v27, v31 row_ror:10 row_mask:0xf bank_mask:0xf
    s_nop 1
    v_mfma_f32_16x16x32_bf16 v[16:19], v[60:63], v[24:27], v[16:19]
    v_mov_b32_dpp v20, v28 row_ror:12 row_mask:0xf bank_mask:0xf
    v_mov_b32_dpp v21, v29 row_ror:12 row_mask:0xf bank_mask:0xf
    v_mov_b32_dpp v22, v30 row_ror:12 row_mask:0xf bank_mask:0xf
    v_mov_b32_dpp v23, v31 row_ror:12 row_mask:0xf bank_mask:0xf
    s_nop 1
    v_mfma_f32_16x16x32_bf16 v[16:19], v[64:67], v[20:23], v[16:19]
    v_mov_b32_dpp v24, v28 row_ror:14 row_mask:0xf bank_mask:0xf
    v_mov_b32_dpp v25, v29 row_ror:14 row_mask:0xf bank_mask:0xf
    v_mov_b32_dpp v26, v30 row_ror:14 row_mask:0xf bank_mask:0xf
    v_mov_b32_dpp v27, v31 row_ror:14 row_mask:0xf bank_mask:0xf
    s_nop 1
    v_mfma_f32_16x16x32_bf16 v[16:19], v[68:71], v[24:27], v[16:19]
    s_mov_b32 m0, s85
    s_add_u32 s85, s85, 4096
    s_mov_b64 exec, s[36:37]
    buffer_load_dwordx4 v38, s[32:35], s84 offen lds
    s_mov_b64 exec, -1
    s_add_u32 s84, s84, 229376
    s_mov_b32 m0, s85
    s_add_u32 s85, s85, 4096
    s_mov_b64 exec, s[36:37]
    buffer_load_dwordx4 v38, s[32:35], s84 offen lds
    s_mov_b64 exec, -1
    s_add_u32 s84, s84, 229376
    s_mov_b32 m0, s85
    s_add_u32 s85, s85, 4096
    s_mov_b64 exec, s[36:37]
    buffer_load_dwordx4 v38, s[32:35], s84 offen lds
    s_mov_b64 exec, -1
    s_add_u32 s84, s84, 229376
    s_mov_b32 m0, s85
    s_add_u32 s85, s85, 4096
    s_mov_b64 exec, s[36:37]
    buffer_load_dwordx4 v38, s[32:35], s84 offen lds
    s_mov_b64 exec, -1
    s_add_u32 s84, s84, 229376
    s_mov_b32 m0, s89
    s_add_u32 s89, s89, 1024
    s_mov_b64 exec, s[94:95]
    buffer_load_dwordx4 v36, s[40:43], s88 offen lds
    s_mov_b64 exec, -1
    s_add_u32 s88, s88, 0
    s_setprio 0
    s_waitcnt vmcnt(17)
    v_perm_b32 v72, v108, v104, s6
    v_perm_b32 v76, v108, v104, s7
    v_perm_b32 v80, v109, v105, s6
    v_perm_b32 v84, v109, v105, s7
    v_perm_b32 v88, v110, v106, s6
    v_perm_b32 v92, v110, v106, s7
    v_perm_b32 v96, v111, v107, s6
    v_perm_b32 v100, v111, v107, s7
    s_waitcnt vmcnt(12)
    v_perm_b32 v73, v116, v112, s6
    v_perm_b32 v77, v116, v112, s7
    v_perm_b32 v81, v117, v113, s6
    v_perm_b32 v85, v117, v113, s7
    v_perm_b32 v89, v118, v114, s6
    v_perm_b32 v93, v118, v114, s7
    v_perm_b32 v97, v119, v115, s6
    v_perm_b32 v101, v119, v115, s7
    s_waitcnt vmcnt(10)
    v_perm_b32 v74, v124, v120, s6
    v_perm_b32 v78, v124, v120, s7
    v_perm_b32 v82, v125, v121, s6
    v_perm_b32 v86, v125, v121, s7
    v_perm_b32 v90, v126, v122, s6
    v_perm_b32 v94, v126, v122, s7
    v_perm_b32 v98, v127, v123, s6
    v_perm_b32 v102, v127, v123, s7
    s_waitcnt vmcnt(8)
    v_perm_b32 v75, v132, v128, s6
    v_perm_b32 v79, v132, v128, s7
    v_perm_b32 v83, v133, v129, s6
    v_perm_b32 v87, v133, v129, s7
    v_perm_b32 v91, v134, v130, s6
    v_perm_b32 v95, v134, v130, s7
    v_perm_b32 v99, v135, v131, s6
    v_perm_b32 v103, v135, v131, s7
    v_mfma_f32_16x16x32_bf16 v[36:39], v[72:75], v[28:31], 0
    v_mov_b32_dpp v24, v28 row_ror:2 row_mask:0xf bank_mask:0xf
    v_mov_b32_dpp v25, v29 row_ror:2 row_mask:0xf bank_mask:0xf
    v_mov_b32_dpp v26, v30 row_ror:2 row_mask:0xf bank_mask:0xf
    v_mov_b32_dpp v27, v31 row_ror:2 row_mask:0xf bank_mask:0xf
    s_nop 1
    v_mfma_f32_16x16x32_bf16 v[36:39], v[76:79], v[24:27], v[36:39]
    v_mov_b32_dpp v20, v28 row_ror:4 row_mask:0xf bank_mask:0xf
    v_mov_b32_dpp v21, v29 row_ror:4 row_mask:0xf bank_mask:0xf
    v_mov_b32_dpp v22, v30 row_ror:4 row_mask:0xf bank_mask:0xf
    v_mov_b32_dpp v23, v31 row_ror:4 row_mask:0xf bank_mask:0xf
    s_nop 1
    v_mfma_f32_16x16x32_bf16 v[36:39], v[80:83], v[20:23], v[36:39]
    v_mov_b32_dpp v24, v28 row_ror:6 row_mask:0xf bank_mask:0xf
    v_mov_b32_dpp v25, v29 row_ror:6 row_mask:0xf bank_mask:0xf
    v_mov_b32_dpp v26, v30 row_ror:6 row_mask:0xf bank_mask:0xf
    v_mov_b32_dpp v27, v31 row_ror:6 row_mask:0xf bank_mask:0xf
    s_nop 1
    v_mfma_f32_16x16x32_bf16 v[36:39], v[84:87], v[24:27], v[36:39]
    v_mov_b32_dpp v20, v28 row_ror:8 row_mask:0xf bank_mask:0xf
    v_mov_b32_dpp v21, v29 row_ror:8 row_mask:0xf bank_mask:0xf
    v_mov_b32_dpp v22, v30 row_ror:8 row_mask:0xf bank_mask:0xf
    v_mov_b32_dpp v23, v31 row_ror:8 row_mask:0xf bank_mask:0xf
    s_nop 1
    v_mfma_f32_16x16x32_bf16 v[36:39], v[88:91], v[20:23], v[36:39]
    v_mov_b32_dpp v24, v28 row_ror:10 row_mask:0xf bank_mask:0xf
    v_mov_b32_dpp v25, v29 row_ror:10 row_mask:0xf bank_mask:0xf
    v_mov_b32_dpp v26, v30 row_ror:10 row_mask:0xf bank_mask:0xf
    v_mov_b32_dpp v27, v31 row_ror:10 row_mask:0xf bank_mask:0xf
    s_nop 1
    v_mfma_f32_16x16x32_bf16 v[36:39], v[92:95], v[24:27], v[36:39]
    v_mov_b32_dpp v20, v28 row_ror:12 row_mask:0xf bank_mask:0xf
    v_mov_b32_dpp v21, v29 row_ror:12 row_mask:0xf bank_mask:0xf
    v_mov_b32_dpp v22, v30 row_ror:12 row_mask:0xf bank_mask:0xf
    v_mov_b32_dpp v23, v31 row_ror:12 row_mask:0xf bank_mask:0xf
    s_nop 1
    v_mfma_f32_16x16x32_bf16 v[36:39], v[96:99], v[20:23], v[36:39]
    v_mov_b32_dpp v24, v28 row_ror:14 row_mask:0xf bank_mask:0xf
    v_mov_b32_dpp v25, v29 row_ror:14 row_mask:0xf bank_mask:0xf
    v_mov_b32_dpp v26, v30 row_ror:14 row_mask:0xf bank_mask:0xf
    v_mov_b32_dpp v27, v31 row_ror:14 row_mask:0xf bank_mask:0xf
    s_nop 1
    v_mfma_f32_16x16x32_bf16 v[36:39], v[100:103], v[24:27], v[36:39]
L_loop:
    v_lshlrev_b32 v20, 4, v0
    v_add_u32 v20, s77, v20
    v_and_b32 v21, 1, v0
    v_lshlrev_b32 v21, 6, v21
    s_lshl_b32 s3, s98, 2
    s_add_u32 s3, s3, 159744
    v_add_u32 v21, s3, v21
    s_mov_b64 exec, 3
    ds_write_b32 v21, v32
    ds_write_b32 v21, v33 offset:32
    s_mov_b64 exec, -1
    ds_write_b128 v20, v[16:19] offset:0
    ds_write_b128 v20, v[36:39] offset:1024
    v_mov_b32 v28, 159884
    s_cmp_ge_u32 s98, 4
    s_cbranch_scc1 Lat_8_b
    v_and_b32 v25, 0x39, v0
    v_lshlrev_b32 v22, 3, v25
    v_bfe_u32 v26, v0, 2, 1
    v_lshl_add_u32 v22, v26, 4, v22
    v_and_b32 v25, 2, v0
    v_lshl_add_u32 v22, v25, 4, v22
    s_lshl_b32 s3, s98, 9
    s_add_u32 s3, s3, 61440
    v_add_u32 v22, s3, v22
    v_lshlrev_b32 v23, 6, v26
    v_add_u32 v23, 159744, v23
Lat_8_b:
    s_waitcnt lgkmcnt(0)
    s_barrier
    ds_read_b32 v21, v28
    s_cmp_ge_u32 s98, 4
    s_cbranch_scc1 Lat_8_e
    ds_read_b128 v[104:107], v23 offset:0
    ds_read_b128 v[108:111], v23 offset:16
    ds_read_b64 v[120:121], v22 offset:0
    ds_read_b64 v[122:123], v22 offset:8192
    ds_read_b64 v[124:125], v22 offset:16384
    ds_read_b64 v[126:127], v22 offset:24576
    ds_read_b64 v[128:129], v22 offset:32768
    ds_read_b64 v[130:131], v22 offset:40960
    ds_read_b64 v[132:133], v22 offset:49152
    ds_read_b64 v[134:135], v22 offset:57344
    ds_read_b128 v[112:115], v23 offset:32
    ds_read_b128 v[116:119], v23 offset:48
    v_lshrrev_b32 v24, 3, v0
    v_lshlrev_b32 v24, 8, v24
    v_lshl_add_u32 v24, v26, 13, v24
    v_and_b32 v25, 3, v0
    v_lshl_add_u32 v24, v25, 2, v24
    v_lshlrev_b32 v27, 7, v26
    s_lshl_b32 s5, s96, 1
    s_lshr_b32 s3, s97, 4
    s_add_u32 s5, s5, s3
    s_lshl_b32 s6, s5, 8
    s_lshl_b32 s5, s5, 14
    s_and_b32 s3, s97, 15
    s_lshl_b32 s4, s3, 3
    s_add_u32 s6, s6, s4
    s_lshl_b32 s4, s3, 4
    s_add_u32 s5, s5, s4
    s_lshl_b32 s4, s98, 11
    s_add_u32 s5, s5, s4
    s_add_u32 s5, s5, s99
    s_add_u32 s6, s6, s99
    s_add_u32 s6, s6, 0x68000
    s_waitcnt lgkmcnt(10)
    v_readfirstlane_b32 s100, v21
    v_max3_f32 v16, v104, v105, v106
    v_max3_f32 v17, v107, v108, v109
    v_max3_f32 v16, v16, v110, v111
    v_max_f32 v16, v16, v17
    v_sub_f32 v104, v104, v16
    v_sub_f32 v105, v105, v16
    v_sub_f32 v106, v106, v16
    v_sub_f32 v107, v107, v16
    v_sub_f32 v108, v108, v16
    v_sub_f32 v109, v109, v16
    v_sub_f32 v110, v110, v16
    v_sub_f32 v111, v111, v16
    v_exp_f32 v104, v104
    v_exp_f32 v105, v105
    v_exp_f32 v106, v106
    v_exp_f32 v107, v107
    v_exp_f32 v108, v108
    v_exp_f32 v109, v109
    v_exp_f32 v110, v110
    v_exp_f32 v111, v111
    s_waitcnt lgkmcnt(2)
    v_mul_f32 v18, v104, v120
    v_mul_f32 v19, v104, v121
    v_fmac_f32 v18, v105, v122
    v_fmac_f32 v19, v105, v123
    v_fmac_f32 v18, v106, v124
    v_fmac_f32 v19, v106, v125
    v_fmac_f32 v18, v107, v126
    v_fmac_f32 v19, v107, v127
    v_fmac_f32 v18, v108, v128
    v_fmac_f32 v19, v108, v129
    v_fmac_f32 v18, v109, v130
    v_fmac_f32 v19, v109, v131
    v_fmac_f32 v18, v110, v132
    v_fmac_f32 v19, v110, v133
    v_fmac_f32 v18, v111, v134
    v_fmac_f32 v19, v111, v135
    v_cvt_pk_bf16_f32 v18, v18, v19
    v_min_u32 v18, -2, v18
    s_cmp_eq_u32 s100, 0
    s_cbranch_scc1 Ls_9_slow
    buffer_store_dword v18, v24, s[20:23], s5 offen
    s_branch Ls_9_done
Ls_9_slow:
    buffer_store_dword v18, v24, s[20:23], s5 offen sc1
Ls_9_done:
    s_cmp_lg_u32 s98, 0
    s_cbranch_scc1 Lat_8_e
    s_waitcnt lgkmcnt(0)
    v_mul_f32 v17, v104, v112
    v_fmac_f32 v17, v105, v113
    v_fmac_f32 v17, v106, v114
    v_fmac_f32 v17, v107, v115
    v_fmac_f32 v17, v108, v116
    v_fmac_f32 v17, v109, v117
    v_fmac_f32 v17, v110, v118
    v_fmac_f32 v17, v111, v119
    v_min_u32 v16, -2, v16
    v_min_u32 v17, -2, v17
    s_mov_b64 exec, 0x11
    s_cmp_eq_u32 s100, 0
    s_cbranch_scc1 Ls_10_slow
    buffer_store_dwordx2 v[16:17], v27, s[20:23], s6 offen
    s_branch Ls_10_done
Ls_10_slow:
    buffer_store_dwordx2 v[16:17], v27, s[20:23], s6 offen sc1
Ls_10_done:
    s_mov_b64 exec, -1
Lat_8_e:
    s_waitcnt lgkmcnt(0)
    v_readfirstlane_b32 s100, v21
    s_mov_b32 s7, s91
    v_lshlrev_b32 v22, 4, v0
    v_lshlrev_b32 v23, 3, v2
    s_lshl_b32 s3, s96, 1
    s_lshr_b32 s4, s97, 4
    s_add_u32 s3, s3, s4
    s_lshl_b32 s5, s3, 14
    s_lshl_b32 s4, s98, 11
    s_add_u32 s5, s5, s4
    s_add_u32 s5, s5, s99
    s_lshl_b32 s6, s3, 8
    s_lshr_b32 s4, s98, 2
    s_lshl_b32 s4, s4, 7
    s_add_u32 s6, s6, s4
    s_add_u32 s6, s6, s99
    s_add_u32 s6, s6, 0x68000
    v_lshrrev_b32 v21, 2, v2
    v_lshlrev_b32 v20, 9, v21
    v_lshl_add_u32 v20, v1, 7, v20
    v_and_b32 v25, 3, v2
    v_lshl_add_u32 v20, v25, 3, v20
    s_lshl_b32 s3, s98, 12
    s_add_u32 s3, s3, 126976
    v_add_u32 v20, s3, v20
    v_lshlrev_b32 v24, 6, v21
    v_lshl_add_u32 v24, v1, 4, v24
    v_add_u32 v24, s77, v24
    v_lshlrev_b32 v25, 3, v0
    v_add_u32 v25, 61440, v25
    v_lshlrev_b32 v26, 2, v0
    s_lshr_b32 s3, s97, 4
    s_mul_i32 s10, s3, 28672
    s_mul_i32 s3, s96, 3584
    s_add_u32 s10, s10, s3
    s_lshl_b32 s3, s7, 8
    s_add_u32 s10, s10, s3
    s_add_u32 s10, s10, s99
    s_add_u32 s10, s10, 0x40000
    s_mov_b32 s8, 0x11111111
    s_mov_b32 s9, 0x11111111
    ds_read_b64_tr_b16 v[104:105], v20 offset:0
    ds_read_b64_tr_b16 v[106:107], v20 offset:64
    ds_read_b64_tr_b16 v[108:109], v20 offset:32
    ds_read_b64_tr_b16 v[110:111], v20 offset:96
    ds_read_b64_tr_b16 v[112:113], v20 offset:2048
    ds_read_b64_tr_b16 v[114:115], v20 offset:2112
    ds_read_b64_tr_b16 v[116:117], v20 offset:2080
    ds_read_b64_tr_b16 v[118:119], v20 offset:2144
    s_barrier
    buffer_load_dwordx2 v[128:129], v23, s[20:23], s6 offen offset:0 sc1
    buffer_load_dwordx4 v[120:123], v22, s[20:23], s5 offen offset:0 sc1
    buffer_load_dwordx4 v[124:127], v22, s[20:23], s5 offen offset:1024 sc1
Lg_12:
    s_waitcnt vmcnt(0)
    v_max3_u32 v21, v128, v129, v120
    v_max3_u32 v21, v21, v121, v122
    v_max3_u32 v21, v21, v123, v124
    v_max3_u32 v21, v21, v125, v126
    v_max_u32 v21, v21, v127
    v_cmp_eq_u32 vcc, -1, v21
    s_cbranch_vccz Lg_12_ok
    s_sub_u32 s101, s101, 1
    s_cbranch_scc1 Lg_12_to
    s_mov_b64 exec, vcc
    buffer_load_dwordx2 v[128:129], v23, s[20:23], s6 offen offset:0 sc1
    buffer_load_dwordx4 v[120:123], v22, s[20:23], s5 offen offset:0 sc1
    buffer_load_dwordx4 v[124:127], v22, s[20:23], s5 offen offset:1024 sc1
    s_mov_b64 exec, -1
    s_branch Lg_12
Lg_12_to:
    s_mov_b32 s101, 0
Lg_12_ok:
    s_waitcnt lgkmcnt(0)
    v_mfma_f32_16x16x32_bf16 v[16:19], v[104:107], v[120:123], 0
    v_max_f32_dpp v28, v128, v128 quad_perm:[1,0,3,2] row_mask:0xf bank_mask:0xf
    v_mfma_f32_16x16x32_bf16 v[36:39], v[108:111], v[120:123], 0
    s_nop 0
    v_max_f32_dpp v28, v28, v28 quad_perm:[2,3,0,1] row_mask:0xf bank_mask:0xf
    v_mfma_f32_16x16x32_bf16 v[16:19], v[112:115], v[124:127], v[16:19]
    v_sub_f32 v28, v128, v28
    v_mfma_f32_16x16x32_bf16 v[36:39], v[116:119], v[124:127], v[36:39]
    v_exp_f32 v28, v28
    s_nop 0
    v_mul_f32 v29, v28, v129
    s_nop 1
    v_add_f32_dpp v29, v29, v29 quad_perm:[1,0,3,2] row_mask:0xf bank_mask:0xf
    s_nop 1
    v_add_f32_dpp v29, v29, v29 quad_perm:[2,3,0,1] row_mask:0xf bank_mask:0xf
    v_rcp_f32 v29, v29
    s_nop 0
    v_mul_f32 v28, v28, v29
    v_mul_f32 v16, v28, v16
    v_mul_f32 v17, v28, v17
    v_mul_f32 v18, v28, v18
    v_mul_f32 v19, v28, v19
    v_mul_f32 v36, v28, v36
    v_mul_f32 v37, v28, v37
    v_mul_f32 v38, v28, v38
    v_mul_f32 v39, v28, v39
    v_add_f32_dpp v16, v16, v16 quad_perm:[1,0,3,2] row_mask:0xf bank_mask:0xf
    v_add_f32_dpp v17, v17, v17 quad_perm:[1,0,3,2] row_mask:0xf bank_mask:0xf
    v_add_f32_dpp v18, v18, v18 quad_perm:[1,0,3,2] row_mask:0xf bank_mask:0xf
    v_add_f32_dpp v19, v19, v19 quad_perm:[1,0,3,2] row_mask:0xf bank_mask:0xf
    v_add_f32_dpp v36, v36, v36 quad_perm:[1,0,3,2] row_mask:0xf bank_mask:0xf
    v_add_f32_dpp v37, v37, v37 quad_perm:[1,0,3,2] row_mask:0xf bank_mask:0xf
    v_add_f32_dpp v38, v38, v38 quad_perm:[1,0,3,2] row_mask:0xf bank_mask:0xf
    v_add_f32_dpp v39, v39, v39 quad_perm:[1,0,3,2] row_mask:0xf bank_mask:0xf
    v_add_f32_dpp v16, v16, v16 quad_perm:[2,3,0,1] row_mask:0xf bank_mask:0xf
    v_add_f32_dpp v17, v17, v17 quad_perm:[2,3,0,1] row_mask:0xf bank_mask:0xf
    v_add_f32_dpp v18, v18, v18 quad_perm:[2,3,0,1] row_mask:0xf bank_mask:0xf
    v_add_f32_dpp v19, v19, v19 quad_perm:[2,3,0,1] row_mask:0xf bank_mask:0xf
    v_add_f32_dpp v36, v36, v36 quad_perm:[2,3,0,1] row_mask:0xf bank_mask:0xf
    v_add_f32_dpp v37, v37, v37 quad_perm:[2,3,0,1] row_mask:0xf bank_mask:0xf
    v_add_f32_dpp v38, v38, v38 quad_perm:[2,3,0,1] row_mask:0xf bank_mask:0xf
    v_add_f32_dpp v39, v39, v39 quad_perm:[2,3,0,1] row_mask:0xf bank_mask:0xf
    s_mov_b64 exec, s[8:9]
    ds_write_b128 v24, v[16:19] offset:2048
    ds_write_b128 v24, v[36:39] offset:2304
    s_mov_b64 exec, -1
    s_waitcnt lgkmcnt(0)
    s_barrier
    s_cmp_lg_u32 s98, 7
    s_cbranch_scc1 Lo_11_skip
    ds_read_b64 v[104:105], v25 offset:2048
    ds_read_b64 v[106:107], v25 offset:10240
    ds_read_b64 v[108:109], v25 offset:18432
    ds_read_b64 v[110:111], v25 offset:26624
    ds_read_b64 v[112:113], v25 offset:34816
    ds_read_b64 v[114:115], v25 offset:43008
    ds_read_b64 v[116:117], v25 offset:51200
    ds_read_b64 v[118:119], v25 offset:59392
    s_waitcnt lgkmcnt(4)
    v_pk_add_f32 v[104:105], v[104:105], v[106:107]
    v_pk_add_f32 v[108:109], v[108:109], v[110:111]
    s_waitcnt lgkmcnt(0)
    v_pk_add_f32 v[112:113], v[112:113], v[114:115]
    v_pk_add_f32 v[116:117], v[116:117], v[118:119]
    v_pk_add_f32 v[104:105], v[104:105], v[108:109]
    v_pk_add_f32 v[112:113], v[112:113], v[116:117]
    v_pk_add_f32 v[104:105], v[104:105], v[112:113]
    v_cvt_pk_bf16_f32 v16, v104, v105
    v_min_u32 v16, -2, v16
    s_mov_b64 exec, s[38:39]
    buffer_store_dword v16, v26, s[20:23], s10 offen sc1
    s_mov_b64 exec, -1
Lo_11_skip:
    s_barrier
    s_cmp_lg_u32 s74, 0
    s_cbranch_scc1 Lgs_13_ngo
    s_cmp_lt_u32 s98, 7
    s_cbranch_scc1 Lgs_13_ngo
    v_lshrrev_b32 v20, 2, v2
    v_lshl_add_u32 v20, v1, 3, v20
    v_lshlrev_b32 v20, 6, v20
    v_and_b32 v21, 1, v2
    v_lshl_add_u32 v20, v21, 3, v20
    v_bfe_u32 v21, v2, 1, 1
    v_mul_u32_u24 v21, 28672, v21
    v_add_u32 v20, v20, v21
    s_and_b32 s3, s98, 3
    v_xor_b32 v21, s3, v1
    v_lshl_add_u32 v20, v21, 4, v20
    ds_read_b64_tr_b16 a[64:65], v20 offset:4096
    ds_read_b64_tr_b16 a[66:67], v20 offset:4352
    ds_read_b64_tr_b16 a[68:69], v20 offset:6144
    ds_read_b64_tr_b16 a[70:71], v20 offset:6400
    ds_read_b64_tr_b16 a[72:73], v20 offset:8192
    ds_read_b64_tr_b16 a[74:75], v20 offset:8448
    ds_read_b64_tr_b16 a[76:77], v20 offset:10240
    ds_read_b64_tr_b16 a[78:79], v20 offset:10496
    ds_read_b64_tr_b16 a[80:81], v20 offset:12288
    ds_read_b64_tr_b16 a[82:83], v20 offset:12544
    ds_read_b64_tr_b16 a[84:85], v20 offset:14336
    ds_read_b64_tr_b16 a[86:87], v20 offset:14592
    ds_read_b64_tr_b16 a[88:89], v20 offset:16384
    ds_read_b64_tr_b16 a[90:91], v20 offset:16640
    ds_read_b64_tr_b16 a[92:93], v20 offset:18432
    ds_read_b64_tr_b16 a[94:95], v20 offset:18688
    ds_read_b64_tr_b16 a[96:97], v20 offset:20480
    ds_read_b64_tr_b16 a[98:99], v20 offset:20736
    ds_read_b64_tr_b16 a[100:101], v20 offset:22528
    ds_read_b64_tr_b16 a[102:103], v20 offset:22784
    ds_read_b64_tr_b16 a[104:105], v20 offset:24576
    ds_read_b64_tr_b16 a[106:107], v20 offset:24832
    ds_read_b64_tr_b16 a[108:109], v20 offset:26624
    ds_read_b64_tr_b16 a[110:111], v20 offset:26880
    ds_read_b64_tr_b16 a[112:113], v20 offset:28672
    ds_read_b64_tr_b16 a[114:115], v20 offset:28928
    ds_read_b64_tr_b16 a[116:117], v20 offset:30720
    ds_read_b64_tr_b16 a[118:119], v20 offset:30976
    v_mov_b32 v32, 0x3f803f80
    v_mov_b32 v33, 0x3f803f80
    v_mov_b32 v34, 0x3f803f80
    v_mov_b32 v35, 0x3f803f80
    s_waitcnt lgkmcnt(0)
    s_nop 0
    v_mfma_f32_16x16x32_bf16 v[8:11], a[64:67], v[32:35], 0
    v_mfma_f32_16x16x32_bf16 v[8:11], a[68:71], v[32:35], v[8:11]
    v_mfma_f32_16x16x32_bf16 v[8:11], a[72:75], v[32:35], v[8:11]
    v_mfma_f32_16x16x32_bf16 v[8:11], a[76:79], v[32:35], v[8:11]
    v_mfma_f32_16x16x32_bf16 v[8:11], a[80:83], v[32:35], v[8:11]
    v_mfma_f32_16x16x32_bf16 v[8:11], a[84:87], v[32:35], v[8:11]
    v_mfma_f32_16x16x32_bf16 v[8:11], a[88:91], v[32:35], v[8:11]
    v_mfma_f32_16x16x32_bf16 v[8:11], a[92:95], v[32:35], v[8:11]
    v_mfma_f32_16x16x32_bf16 v[8:11], a[96:99], v[32:35], v[8:11]
    v_mfma_f32_16x16x32_bf16 v[8:11], a[100:103], v[32:35], v[8:11]
    v_mfma_f32_16x16x32_bf16 v[8:11], a[104:107], v[32:35], v[8:11]
    v_mfma_f32_16x16x32_bf16 v[8:11], a[108:111], v[32:35], v[8:11]
    v_mfma_f32_16x16x32_bf16 v[8:11], a[112:115], v[32:35], v[8:11]
    v_mfma_f32_16x16x32_bf16 v[8:11], a[116:119], v[32:35], v[8:11]
    s_cmp_lg_u32 s98, 7
    s_cbranch_scc1 Lgs_13_ngo
    s_lshl_b32 s3, s96, 5
    s_add_u32 s3, s3, s97
    s_lshl_b32 s4, s3, 10
    v_lshlrev_b32 v20, 7, v0
    v_add_u32 v21, s4, v20
    s_lshl_b32 s4, s3, 7
    s_add_u32 s4, s4, 0x60000
    v_writelane_b32 v21, s4, 8
    s_lshl_b32 s4, s3, 4
    s_add_u32 s4, s4, 0x68000
    v_writelane_b32 v21, s4, 9
    s_lshl_b32 s4, s3, 8
    s_add_u32 s4, s4, 0x78000
    v_writelane_b32 v21, s4, 10
    s_add_u32 s4, s4, 128
    v_writelane_b32 v21, s4, 11
    s_mov_b32 s4, 0x78000
    s_mov_b64 exec, 0xfff
    buffer_load_dword v38, v21, s[20:23], s4 offen sc1
    s_mov_b64 exec, 1
    buffer_load_dword v36, v0, s[48:51], 0 offen
    s_mov_b64 exec, -1
Lgs_13_ngo:
    v_and_b32 v30, 1, v2
    v_mul_u32_u24 v30, 896, v30
    v_lshl_add_u32 v30, v1, 4, v30
    v_lshlrev_b32 v31, 4, v2
    v_and_b32 v22, 1, v2
    v_lshlrev_b32 v22, 4, v22
    v_and_b32 v23, 1, v1
    v_lshl_add_u32 v22, v23, 3, v22
    v_lshrrev_b32 v23, 1, v1
    v_lshl_add_u32 v22, v23, 2, v22
    s_lshl_b32 s5, s96, 12
    s_lshr_b32 s3, s97, 3
    s_lshl_b32 s3, s3, 5
    s_add_u32 s5, s5, s3
    s_mov_b32 s7, s90
    s_lshr_b32 s3, s7, 1
    s_lshl_b32 s3, s3, 10
    s_add_u32 s5, s5, s3
    s_and_b32 s3, s7, 1
    s_lshl_b32 s3, s3, 7
    s_add_u32 s5, s5, s3
    s_and_b32 s3, s98, 3
    s_lshl_b32 s3, s3, 8
    s_add_u32 s5, s5, s3
    s_add_u32 s5, s5, s99
    s_add_u32 s5, s5, 0x60000
    s_cmp_eq_u32 s98, 7
    s_cbranch_scc1 Lgs_13_b
    v_and_b32 v27, 2, v2
    v_and_b32 v26, 1, v1
    v_add_lshl_u32 v27, v27, v26, 3
    s_lshl_b32 s3, s98, 5
    v_add_u32 v27, s3, v27
    v_mov_b32 v26, 0x3f803f80
    s_mov_b32 s8, 0x00050005
    s_mov_b32 s9, 0
    v_lshrrev_b32 v24, 2, v2
    v_lshlrev_b32 v24, 5, v24
    v_and_b32 v25, 1, v2
    v_lshl_add_u32 v24, v25, 4, v24
    v_and_b32 v25, 1, v1
    v_lshl_add_u32 v24, v25, 3, v24
    v_bfe_u32 v25, v2, 1, 1
    v_mul_u32_u24 v25, 896, v25
    v_add_u32 v24, v24, v25
    s_lshl_b32 s3, s98, 7
    v_add_u32 v24, s3, v24
    v_mul_u32_u24 v23, 3584, v1
    v_lshrrev_b32 v25, 2, v2
    v_lshl_add_u32 v23, v25, 7, v23
    v_and_b32 v25, 3, v2
    v_lshl_add_u32 v23, v25, 4, v23
    s_lshr_b32 s3, s97, 4
    s_mul_i32 s10, s3, 28672
    s_add_u32 s10, s10, s99
    s_bfe_u32 s3, s97, 0x10003
    s_lshl_b32 s3, s3, 6
    s_add_u32 s10, s10, s3
    s_lshl_b32 s3, s98, 9
    s_add_u32 s10, s10, s3
    s_add_u32 s10, s10, 0x40000
    s_add_u32 s11, s10, 14336
    buffer_load_dwordx4 v[104:107], v23, s[20:23], s10 offen offset:0 sc1
    buffer_load_dwordx4 v[108:111], v23, s[20:23], s11 offen offset:0 sc1
    s_cmp_lg_u32 s74, 0
    s_cbranch_scc1 Lgs_13_ngi
    s_cmp_lt_u32 s98, 4
    s_cbranch_scc1 Lgs_13_ngi
    v_lshrrev_b32 v20, 2, v2
    v_lshl_add_u32 v20, v1, 3, v20
    v_lshlrev_b32 v20, 6, v20
    v_and_b32 v21, 1, v2
    v_lshl_add_u32 v20, v21, 3, v20
    v_bfe_u32 v21, v2, 1, 1
    v_mul_u32_u24 v21, 28672, v21
    v_add_u32 v20, v20, v21
    s_and_b32 s3, s98, 3
    v_xor_b32 v21, s3, v1
    v_lshl_add_u32 v20, v21, 4, v20
    ds_read_b64_tr_b16 a[64:65], v20 offset:4096
    ds_read_b64_tr_b16 a[66:67], v20 offset:4352
    ds_read_b64_tr_b16 a[68:69], v20 offset:6144
    ds_read_b64_tr_b16 a[70:71], v20 offset:6400
    ds_read_b64_tr_b16 a[72:73], v20 offset:8192
    ds_read_b64_tr_b16 a[74:75], v20 offset:8448
    ds_read_b64_tr_b16 a[76:77], v20 offset:10240
    ds_read_b64_tr_b16 a[78:79], v20 offset:10496
    ds_read_b64_tr_b16 a[80:81], v20 offset:12288
    ds_read_b64_tr_b16 a[82:83], v20 offset:12544
    ds_read_b64_tr_b16 a[84:85], v20 offset:14336
    ds_read_b64_tr_b16 a[86:87], v20 offset:14592
    ds_read_b64_tr_b16 a[88:89], v20 offset:16384
    ds_read_b64_tr_b16 a[90:91], v20 offset:16640
    ds_read_b64_tr_b16 a[92:93], v20 offset:18432
    ds_read_b64_tr_b16 a[94:95], v20 offset:18688
    ds_read_b64_tr_b16 a[96:97], v20 offset:20480
    ds_read_b64_tr_b16 a[98:99], v20 offset:20736
    ds_read_b64_tr_b16 a[100:101], v20 offset:22528
    ds_read_b64_tr_b16 a[102:103], v20 offset:22784
    ds_read_b64_tr_b16 a[104:105], v20 offset:24576
    ds_read_b64_tr_b16 a[106:107], v20 offset:24832
    ds_read_b64_tr_b16 a[108:109], v20 offset:26624
    ds_read_b64_tr_b16 a[110:111], v20 offset:26880
    ds_read_b64_tr_b16 a[112:113], v20 offset:28672
    ds_read_b64_tr_b16 a[114:115], v20 offset:28928
    ds_read_b64_tr_b16 a[116:117], v20 offset:30720
    ds_read_b64_tr_b16 a[118:119], v20 offset:30976
    v_mov_b32 v32, 0x3f803f80
    v_mov_b32 v33, 0x3f803f80
    v_mov_b32 v34, 0x3f803f80
    v_mov_b32 v35, 0x3f803f80
    s_waitcnt lgkmcnt(0)
    s_nop 0
    v_mfma_f32_16x16x32_bf16 v[8:11], a[64:67], v[32:35], 0
    v_mfma_f32_16x16x32_bf16 v[8:11], a[68:71], v[32:35], v[8:11]
    v_mfma_f32_16x16x32_bf16 v[8:11], a[72:75], v[32:35], v[8:11]
    v_mfma_f32_16x16x32_bf16 v[8:11], a[76:79], v[32:35], v[8:11]
    v_mfma_f32_16x16x32_bf16 v[8:11], a[80:83], v[32:35], v[8:11]
    v_mfma_f32_16x16x32_bf16 v[8:11], a[84:87], v[32:35], v[8:11]
    v_mfma_f32_16x16x32_bf16 v[8:11], a[88:91], v[32:35], v[8:11]
    v_mfma_f32_16x16x32_bf16 v[8:11], a[92:95], v[32:35], v[8:11]
    v_mfma_f32_16x16x32_bf16 v[8:11], a[96:99], v[32:35], v[8:11]
    v_mfma_f32_16x16x32_bf16 v[8:11], a[100:103], v[32:35], v[8:11]
    v_mfma_f32_16x16x32_bf16 v[8:11], a[104:107], v[32:35], v[8:11]
    v_mfma_f32_16x16x32_bf16 v[8:11], a[108:111], v[32:35], v[8:11]
    v_mfma_f32_16x16x32_bf16 v[8:11], a[112:115], v[32:35], v[8:11]
    v_mfma_f32_16x16x32_bf16 v[8:11], a[116:119], v[32:35], v[8:11]
Lgs_13_ngi:
Lg_14:
    s_waitcnt vmcnt(0)
    v_max3_u32 v25, v104, v105, v106
    v_max3_u32 v25, v25, v107, v108
    v_max3_u32 v25, v25, v109, v110
    v_max_u32 v25, v25, v111
    v_cmp_eq_u32 vcc, -1, v25
    s_cbranch_vccz Lg_14_ok
    s_sub_u32 s101, s101, 1
    s_cbranch_scc1 Lg_14_to
    s_mov_b64 exec, vcc
    buffer_load_dwordx4 v[104:107], v23, s[20:23], s10 offen offset:0 sc1
    buffer_load_dwordx4 v[108:111], v23, s[20:23], s11 offen offset:0 sc1
    s_mov_b64 exec, -1
    s_branch Lg_14
Lg_14_to:
    s_mov_b32 s101, 0
Lg_14_ok:
    v_mfma_f32_16x16x32_bf16 v[16:19], v[12:15], v[104:107], v[4:7]
    v_mfma_f32_16x16x32_bf16 v[16:19], v[12:15], v[108:111], v[16:19]
    s_nop 7
    v_cvt_pk_bf16_f32 v28, v16, v17
    v_cvt_pk_bf16_f32 v29, v18, v19
    ds_write_b64 v24, v[28:29] offset:1792
    v_dot2_f32_bf16 v16, v28, v26, 0
    v_dot2_f32_bf16 v17, v28, v28, 0
    v_dot2_f32_bf16 v16, v29, v26, v16
    v_dot2_f32_bf16 v17, v29, v29, v17
    s_nop 2
    v_add_f32_dpp v16, v16, v16 quad_perm:[1,0,3,2] row_mask:0xf bank_mask:0xf
    v_add_f32_dpp v17, v17, v17 quad_perm:[1,0,3,2] row_mask:0xf bank_mask:0xf
    s_nop 0
    v_add_f32_dpp v16, v16, v16 row_ror:4 row_mask:0xf bank_mask:0xf
    v_add_f32_dpp v17, v17, v17 row_ror:4 row_mask:0xf bank_mask:0xf
    s_nop 0
    v_add_f32_dpp v16, v16, v16 row_ror:8 row_mask:0xf bank_mask:0xf
    v_add_f32_dpp v17, v17, v17 row_ror:8 row_mask:0xf bank_mask:0xf
    s_mov_b64 exec, s[8:9]
    ds_write_b64 v27, v[16:17] offset:3840
    s_mov_b64 exec, -1
Lgs_13_b:
    s_waitcnt lgkmcnt(0)
    s_barrier
    s_cmp_lt_u32 s98, 4
    s_cbranch_scc1 Lgs_13_e
    s_cmp_eq_u32 s7, 7
    s_cbranch_scc1 Lgs_13_e
    ds_read_b128 v[104:107], v30 offset:1792
    ds_read_b128 v[108:111], v30 offset:1856
    ds_read_b128 v[32:35], v31 offset:3840
    ds_read_b128 v[112:115], v30 offset:1920
    ds_read_b128 v[116:119], v30 offset:1984
    ds_read_b128 v[120:123], v30 offset:2048
    ds_read_b128 v[124:127], v30 offset:2112
    ds_read_b128 v[128:131], v30 offset:2176
    ds_read_b128 v[132:135], v30 offset:2240
    s_waitcnt lgkmcnt(8)
    v_mfma_f32_16x16x32_bf16 v[16:19], a[64:67], v[104:107], 0
    ds_read_b128 v[104:107], v30 offset:2304
    s_waitcnt lgkmcnt(8)
    v_mfma_f32_16x16x32_bf16 v[16:19], a[68:71], v[108:111], v[16:19]
    ds_read_b128 v[108:111], v30 offset:2368
    s_waitcnt lgkmcnt(7)
    v_mfma_f32_16x16x32_bf16 v[16:19], a[72:75], v[112:115], v[16:19]
    ds_read_b128 v[112:115], v30 offset:2432
    v_add_f32 v20, v32, v34
    v_add_f32 v21, v33, v35
    s_waitcnt lgkmcnt(7)
    v_mfma_f32_16x16x32_bf16 v[16:19], a[76:79], v[116:119], v[16:19]
    ds_read_b128 v[116:119], v30 offset:2496
    v_add_f32_dpp v20, v20, v20 quad_perm:[2,3,0,1] row_mask:0xf bank_mask:0xf
    v_add_f32_dpp v21, v21, v21 quad_perm:[2,3,0,1] row_mask:0xf bank_mask:0xf
    s_waitcnt lgkmcnt(7)
    v_mfma_f32_16x16x32_bf16 v[16:19], a[80:83], v[120:123], v[16:19]
    ds_read_b128 v[120:123], v30 offset:2560
    v_add_f32_dpp v20, v20, v20 row_ror:4 row_mask:0xf bank_mask:0xf
    v_add_f32_dpp v21, v21, v21 row_ror:4 row_mask:0xf bank_mask:0xf
    s_waitcnt lgkmcnt(7)
    v_mfma_f32_16x16x32_bf16 v[16:19], a[84:87], v[124:127], v[16:19]
    ds_read_b128 v[124:127], v30 offset:2624
    v_add_f32_dpp v20, v20, v20 row_ror:8 row_mask:0xf bank_mask:0xf
    v_add_f32_dpp v21, v21, v21 row_ror:8 row_mask:0xf bank_mask:0xf
    s_waitcnt lgkmcnt(7)
    v_mfma_f32_16x16x32_bf16 v[16:19], a[88:91], v[128:131], v[16:19]
    v_mul_f32 v20, 0x3b124925, v20
    v_mul_f32 v21, 0x3b124925, v21
    s_waitcnt lgkmcnt(6)
    v_mfma_f32_16x16x32_bf16 v[16:19], a[92:95], v[132:135], v[16:19]
    v_fma_f32 v21, -v20, v20, v21
    v_max_f32 v21, 0, v21
    s_waitcnt lgkmcnt(5)
    v_mfma_f32_16x16x32_bf16 v[16:19], a[96:99], v[104:107], v[16:19]
    v_add_f32 v21, 0x3727c5ac, v21
    v_rsq_f32 v21, v21
    s_waitcnt lgkmcnt(4)
    v_mfma_f32_16x16x32_bf16 v[16:19], a[100:103], v[108:111], v[16:19]
    v_mul_f32 v32, v20, v8
    v_mul_f32 v33, v20, v9
    s_waitcnt lgkmcnt(3)
    v_mfma_f32_16x16x32_bf16 v[16:19], a[104:107], v[112:115], v[16:19]
    v_mul_f32 v34, v20, v10
    v_mul_f32 v35, v20, v11
    s_waitcnt lgkmcnt(2)
    v_mfma_f32_16x16x32_bf16 v[16:19], a[108:111], v[116:119], v[16:19]
    v_mul_f32 v32, v21, v32
    v_mul_f32 v33, v21, v33
    s_waitcnt lgkmcnt(1)
    v_mfma_f32_16x16x32_bf16 v[16:19], a[112:115], v[120:123], v[16:19]
    v_mul_f32 v34, v21, v34
    v_mul_f32 v35, v21, v35
    s_waitcnt lgkmcnt(0)
    v_mfma_f32_16x16x32_bf16 v[16:19], a[116:119], v[124:127], v[16:19]
    s_nop 7
    v_fma_f32 v16, v21, v16, -v32
    v_fma_f32 v17, v21, v17, -v33
    v_fma_f32 v18, v21, v18, -v34
    v_fma_f32 v19, v21, v19, -v35
    s_nop 0
    v_permlane32_swap_b32 v16, v18
    v_permlane32_swap_b32 v17, v19
    v_mul_f32 v16, 0xbfb8aa3b, v16
    v_mul_f32 v17, 0xbfb8aa3b, v17
    v_exp_f32 v16, v16
    v_exp_f32 v17, v17
    v_add_f32 v16, 1.0, v16
    v_add_f32 v17, 1.0, v17
    v_rcp_f32 v16, v16
    v_rcp_f32 v17, v17
    v_mul_f32 v16, v16, v18
    v_mul_f32 v17, v17, v19
    v_cvt_pk_bf16_f32 v16, v16, v17
    v_min_u32 v16, -2, v16
    s_mov_b64 exec, s[80:81]
    s_cmp_eq_u32 s100, 0
    s_cbranch_scc1 Ls_15_slow
    buffer_store_dword v16, v22, s[20:23], s5 offen
    s_branch Ls_15_done
Ls_15_slow:
    buffer_store_dword v16, v22, s[20:23], s5 offen sc1
Ls_15_done:
    s_mov_b64 exec, -1
Lgs_13_e:
    s_cmp_eq_u32 s98, 0
    s_cbranch_scc1 Lgs_13_nb
    s_barrier
Lgs_13_nb:
    v_lshlrev_b32 v4, 16, v28
    v_and_b32 v5, 0xffff0000, v28
    v_lshlrev_b32 v6, 16, v29
    v_and_b32 v7, 0xffff0000, v29
    s_cmp_lg_u32 s98, 0
    s_cbranch_scc1 Ld_16_e
    v_lshrrev_b32 v16, 2, v2
    v_lshl_add_u32 v16, v1, 3, v16
    v_lshlrev_b32 v16, 5, v16
    v_and_b32 v17, 3, v2
    v_lshl_add_u32 v16, v17, 3, v16
    v_add_u32 v16, 65536, v16
    ds_read_b64_tr_b16 v[104:105], v16 offset:0
    ds_read_b64_tr_b16 v[106:107], v16 offset:128
    ds_read_b64_tr_b16 v[108:109], v16 offset:8192
    ds_read_b64_tr_b16 v[110:111], v16 offset:8320
    ds_read_b64_tr_b16 v[112:113], v16 offset:16384
    ds_read_b64_tr_b16 v[114:115], v16 offset:16512
    ds_read_b64_tr_b16 v[116:117], v16 offset:24576
    ds_read_b64_tr_b16 v[118:119], v16 offset:24704
    ds_read_b64_tr_b16 v[120:121], v16 offset:32768
    ds_read_b64_tr_b16 v[122:123], v16 offset:32896
    ds_read_b64_tr_b16 v[124:125], v16 offset:40960
    ds_read_b64_tr_b16 v[126:127], v16 offset:41088
    ds_read_b64_tr_b16 v[128:129], v16 offset:49152
    ds_read_b64_tr_b16 v[130:131], v16 offset:49280
    v_lshlrev_b32 v132, 4, v0
    v_and_b32 v133, 0x37f, v132
    s_lshl_b32 s5, s96, 12
    s_add_u32 s5, s5, s99
    s_add_u32 s5, s5, 0x60000
    v_bfe_u32 v134, v2, 2, 1
    v_mul_u32_u24 v134, 28672, v134
    v_and_b32 v135, 3, v2
    v_lshl_add_u32 v134, v135, 5, v134
    v_lshl_add_u32 v134, v1, 3, v134
    s_mul_i32 s6, s96, 3584
    s_lshl_b32 s3, s92, 7
    s_add_u32 s6, s6, s3
    s_add_u32 s6, s6, s99
    s_add_u32 s6, s6, 0x50000
    s_mov_b32 s8, 0x00ff00ff
    s_mov_b32 s9, 0x00ff00ff
    s_and_b64 s[8:9], s[8:9], s[94:95]
    s_barrier
    buffer_load_dwordx4 v[20:23], v132, s[20:23], s5 offen offset:0 sc1
    buffer_load_dwordx4 v[24:27], v132, s[20:23], s5 offen offset:1024 sc1
    buffer_load_dwordx4 v[28:31], v132, s[20:23], s5 offen offset:2048 sc1
    buffer_load_dwordx4 v[32:35], v133, s[20:23], s5 offen offset:3072 sc1
Lg_17:
    s_waitcnt vmcnt(0)
    v_max3_u32 v135, v20, v21, v22
    v_max3_u32 v135, v135, v23, v24
    v_max3_u32 v135, v135, v25, v26
    v_max3_u32 v135, v135, v27, v28
    v_max3_u32 v135, v135, v29, v30
    v_max3_u32 v135, v135, v31, v32
    v_max3_u32 v135, v135, v33, v34
    v_max_u32 v135, v135, v35
    v_cmp_eq_u32 vcc, -1, v135
    s_cbranch_vccz Lg_17_ok
    s_sub_u32 s101, s101, 1
    s_cbranch_scc1 Lg_17_to
    s_mov_b64 exec, vcc
    buffer_load_dwordx4 v[20:23], v132, s[20:23], s5 offen offset:0 sc1
    buffer_load_dwordx4 v[24:27], v132, s[20:23], s5 offen offset:1024 sc1
    buffer_load_dwordx4 v[28:31], v132, s[20:23], s5 offen offset:2048 sc1
    buffer_load_dwordx4 v[32:35], v133, s[20:23], s5 offen offset:3072 sc1
    s_mov_b64 exec, -1
    s_branch Lg_17
Lg_17_to:
    s_mov_b32 s101, 0
Lg_17_ok:
    s_waitcnt lgkmcnt(0)
    v_mfma_f32_16x16x32_bf16 v[16:19], v[104:107], v[20:23], 0
    v_mfma_f32_16x16x32_bf16 v[36:39], v[108:111], v[20:23], 0
    v_mfma_f32_16x16x32_bf16 v[16:19], v[112:115], v[24:27], v[16:19]
    v_mfma_f32_16x16x32_bf16 v[36:39], v[116:119], v[24:27], v[36:39]
    v_mfma_f32_16x16x32_bf16 v[16:19], v[120:123], v[28:31], v[16:19]
    v_mfma_f32_16x16x32_bf16 v[36:39], v[124:127], v[28:31], v[36:39]
    v_mfma_f32_16x16x32_bf16 v[16:19], v[128:131], v[32:35], v[16:19]
    s_nop 7
    v_add_f32_dpp v16, v36, v16 row_ror:8 row_mask:0xf bank_mask:0xf
    v_add_f32_dpp v17, v37, v17 row_ror:8 row_mask:0xf bank_mask:0xf
    v_add_f32_dpp v18, v38, v18 row_ror:8 row_mask:0xf bank_mask:0xf
    v_add_f32_dpp v19, v39, v19 row_ror:8 row_mask:0xf bank_mask:0xf
    v_cvt_pk_bf16_f32 v16, v16, v17
    v_cvt_pk_bf16_f32 v17, v18, v19
    v_min_u32 v16, -2, v16
    v_min_u32 v17, -2, v17
    s_mov_b64 exec, s[8:9]
    buffer_store_dwordx2 v[16:17], v134, s[20:23], s6 offen sc1
    s_mov_b64 exec, -1
Ld_16_e:
    s_barrier
    s_cmp_lg_u32 s74, 0
    s_cbranch_scc1 L_last
    s_mov_b32 s74, 1
    s_mov_b32 s99, 0x78000
    v_and_b32 v30, 1, v2
    v_mul_u32_u24 v30, 896, v30
    v_lshl_add_u32 v30, v1, 4, v30
    v_lshlrev_b32 v31, 4, v2
    v_and_b32 v22, 1, v2
    v_lshlrev_b32 v22, 10, v22
    v_lshrrev_b32 v23, 1, v1
    v_lshl_add_u32 v22, v23, 8, v22
    v_and_b32 v23, 1, v1
    v_lshl_add_u32 v22, v23, 3, v22
    s_lshl_b32 s5, s96, 13
    s_add_u32 s5, s5, 0xf0000
    s_lshr_b32 s3, s97, 3
    s_lshl_b32 s3, s3, 11
    s_add_u32 s5, s5, s3
    s_bfe_u32 s3, s97, 0x10001
    s_lshl_b32 s3, s3, 7
    s_add_u32 s5, s5, s3
    s_bfe_u32 s3, s97, 0x10002
    s_lshl_b32 s3, s3, 6
    s_add_u32 s5, s5, s3
    s_bfe_u32 s3, s97, 0x10000
    s_lshl_b32 s3, s3, 5
    s_add_u32 s5, s5, s3
    s_bfe_u32 s3, s98, 0x10001
    s_lshl_b32 s3, s3, 4
    s_add_u32 s5, s5, s3
    s_and_b32 s3, s98, 1
    s_lshl_b32 s3, s3, 9
    s_add_u32 s5, s5, s3
    s_cmp_eq_u32 s98, 7
    s_cbranch_scc1 Lq_18_b
    v_and_b32 v27, 2, v2
    v_and_b32 v26, 1, v1
    v_add_lshl_u32 v27, v27, v26, 3
    s_lshl_b32 s3, s98, 5
    v_add_u32 v27, s3, v27
    v_mov_b32 v26, 0x3f803f80
    s_mov_b32 s8, 0x00050005
    s_mov_b32 s9, 0
    v_lshrrev_b32 v24, 2, v2
    v_lshlrev_b32 v24, 5, v24
    v_and_b32 v25, 1, v2
    v_lshl_add_u32 v24, v25, 4, v24
    v_and_b32 v25, 1, v1
    v_lshl_add_u32 v24, v25, 3, v24
    v_bfe_u32 v25, v2, 1, 1
    v_mul_u32_u24 v25, 896, v25
    v_add_u32 v24, v24, v25
    s_lshl_b32 s3, s98, 7
    v_add_u32 v24, s3, v24
    v_mul_u32_u24 v23, 3584, v1
    v_lshrrev_b32 v25, 2, v2
    v_lshl_add_u32 v23, v25, 7, v23
    v_and_b32 v25, 3, v2
    v_lshl_add_u32 v23, v25, 4, v23
    s_lshr_b32 s3, s97, 4
    s_mul_i32 s10, s3, 28672
    s_add_u32 s10, s10, s99
    s_bfe_u32 s3, s97, 0x10003
    s_lshl_b32 s3, s3, 6
    s_add_u32 s10, s10, s3
    s_lshl_b32 s3, s98, 9
    s_add_u32 s10, s10, s3
    s_add_u32 s10, s10, 0xfffd8000
    s_add_u32 s11, s10, 14336
    buffer_load_dwordx4 v[104:107], v23, s[20:23], s10 offen offset:0 sc1
    buffer_load_dwordx4 v[108:111], v23, s[20:23], s11 offen offset:0 sc1
Lg_19:
    s_waitcnt vmcnt(0)
    v_max3_u32 v25, v104, v105, v106
    v_max3_u32 v25, v25, v107, v108
    v_max3_u32 v25, v25, v109, v110
    v_max_u32 v25, v25, v111
    v_cmp_eq_u32 vcc, -1, v25
    s_cbranch_vccz Lg_19_ok
    s_sub_u32 s101, s101, 1
    s_cbranch_scc1 Lg_19_to
    s_mov_b64 exec, vcc
    buffer_load_dwordx4 v[104:107], v23, s[20:23], s10 offen offset:0 sc1
    buffer_load_dwordx4 v[108:111], v23, s[20:23], s11 offen offset:0 sc1
    s_mov_b64 exec, -1
    s_branch Lg_19
Lg_19_to:
    s_mov_b32 s101, 0
Lg_19_ok:
    v_mfma_f32_16x16x32_bf16 v[16:19], v[12:15], v[104:107], v[4:7]
    v_mfma_f32_16x16x32_bf16 v[16:19], v[12:15], v[108:111], v[16:19]
    s_nop 7
    v_cvt_pk_bf16_f32 v28, v16, v17
    v_cvt_pk_bf16_f32 v29, v18, v19
    ds_write_b64 v24, v[28:29] offset:0
    v_dot2_f32_bf16 v16, v28, v26, 0
    v_dot2_f32_bf16 v17, v28, v28, 0
    v_dot2_f32_bf16 v16, v29, v26, v16
    v_dot2_f32_bf16 v17, v29, v29, v17
    s_nop 2
    v_add_f32_dpp v16, v16, v16 quad_perm:[1,0,3,2] row_mask:0xf bank_mask:0xf
    v_add_f32_dpp v17, v17, v17 quad_perm:[1,0,3,2] row_mask:0xf bank_mask:0xf
    s_nop 0
    v_add_f32_dpp v16, v16, v16 row_ror:4 row_mask:0xf bank_mask:0xf
    v_add_f32_dpp v17, v17, v17 row_ror:4 row_mask:0xf bank_mask:0xf
    s_nop 0
    v_add_f32_dpp v16, v16, v16 row_ror:8 row_mask:0xf bank_mask:0xf
    v_add_f32_dpp v17, v17, v17 row_ror:8 row_mask:0xf bank_mask:0xf
    s_mov_b64 exec, s[8:9]
    ds_write_b64 v27, v[16:17] offset:3584
    s_mov_b64 exec, -1
Lq_18_b:
    s_waitcnt lgkmcnt(0)
    s_barrier
    s_cmp_ge_u32 s98, 4
    s_cbranch_scc1 Lq_18_e
    ds_read_b128 v[104:107], v30 offset:0
    ds_read_b128 v[108:111], v30 offset:64
    ds_read_b128 v[32:35], v31 offset:3584
    ds_read_b128 v[112:115], v30 offset:128
    ds_read_b128 v[116:119], v30 offset:192
    ds_read_b128 v[120:123], v30 offset:256
    ds_read_b128 v[124:127], v30 offset:320
    ds_read_b128 v[128:131], v30 offset:384
    ds_read_b128 v[132:135], v30 offset:448
    s_waitcnt lgkmcnt(8)
    v_mfma_f32_16x16x32_bf16 v[16:19], a[64:67], v[104:107], 0
    ds_read_b128 v[104:107], v30 offset:512
    s_waitcnt lgkmcnt(8)
    v_mfma_f32_16x16x32_bf16 v[16:19], a[68:71], v[108:111], v[16:19]
    ds_read_b128 v[108:111], v30 offset:576
    s_waitcnt lgkmcnt(7)
    v_mfma_f32_16x16x32_bf16 v[16:19], a[72:75], v[112:115], v[16:19]
    ds_read_b128 v[112:115], v30 offset:640
    v_add_f32 v20, v32, v34
    v_add_f32 v21, v33, v35
    s_waitcnt lgkmcnt(7)
    v_mfma_f32_16x16x32_bf16 v[16:19], a[76:79], v[116:119], v[16:19]
    ds_read_b128 v[116:119], v30 offset:704
    v_add_f32_dpp v20, v20, v20 quad_perm:[2,3,0,1] row_mask:0xf bank_mask:0xf
    v_add_f32_dpp v21, v21, v21 quad_perm:[2,3,0,1] row_mask:0xf bank_mask:0xf
    s_waitcnt lgkmcnt(7)
    v_mfma_f32_16x16x32_bf16 v[16:19], a[80:83], v[120:123], v[16:19]
    ds_read_b128 v[120:123], v30 offset:768
    v_add_f32_dpp v20, v20, v20 row_ror:4 row_mask:0xf bank_mask:0xf
    v_add_f32_dpp v21, v21, v21 row_ror:4 row_mask:0xf bank_mask:0xf
    s_waitcnt lgkmcnt(7)
    v_mfma_f32_16x16x32_bf16 v[16:19], a[84:87], v[124:127], v[16:19]
    ds_read_b128 v[124:127], v30 offset:832
    v_add_f32_dpp v20, v20, v20 row_ror:8 row_mask:0xf bank_mask:0xf
    v_add_f32_dpp v21, v21, v21 row_ror:8 row_mask:0xf bank_mask:0xf
    s_waitcnt lgkmcnt(7)
    v_mfma_f32_16x16x32_bf16 v[16:19], a[88:91], v[128:131], v[16:19]
    v_mul_f32 v20, 0x3b124925, v20
    v_mul_f32 v21, 0x3b124925, v21
    s_waitcnt lgkmcnt(6)
    v_mfma_f32_16x16x32_bf16 v[16:19], a[92:95], v[132:135], v[16:19]
    v_fma_f32 v21, -v20, v20, v21
    v_max_f32 v21, 0, v21
    s_waitcnt lgkmcnt(5)
    v_mfma_f32_16x16x32_bf16 v[16:19], a[96:99], v[104:107], v[16:19]
    v_add_f32 v21, 0x3727c5ac, v21
    v_rsq_f32 v21, v21
    s_waitcnt lgkmcnt(4)
    v_mfma_f32_16x16x32_bf16 v[16:19], a[100:103], v[108:111], v[16:19]
    v_mul_f32 v32, v20, v8
    v_mul_f32 v33, v20, v9
    s_waitcnt lgkmcnt(3)
    v_mfma_f32_16x16x32_bf16 v[16:19], a[104:107], v[112:115], v[16:19]
    v_mul_f32 v34, v20, v10
    v_mul_f32 v35, v20, v11
    s_waitcnt lgkmcnt(2)
    v_mfma_f32_16x16x32_bf16 v[16:19], a[108:111], v[116:119], v[16:19]
    v_mul_f32 v32, v21, v32
    v_mul_f32 v33, v21, v33
    s_waitcnt lgkmcnt(1)
    v_mfma_f32_16x16x32_bf16 v[16:19], a[112:115], v[120:123], v[16:19]
    v_mul_f32 v34, v21, v34
    v_mul_f32 v35, v21, v35
    s_waitcnt lgkmcnt(0)
    v_mfma_f32_16x16x32_bf16 v[16:19], a[116:119], v[124:127], v[16:19]
    s_nop 7
    v_fma_f32 v16, v21, v16, -v32
    v_fma_f32 v17, v21, v17, -v33
    v_fma_f32 v18, v21, v18, -v34
    v_fma_f32 v19, v21, v19, -v35
    v_cvt_pk_bf16_f32 v16, v16, v17
    v_cvt_pk_bf16_f32 v17, v18, v19
    v_min_u32 v16, -2, v16
    v_min_u32 v17, -2, v17
    s_mov_b64 exec, s[80:81]
    s_cmp_eq_u32 s100, 0
    s_cbranch_scc1 Ls_20_slow
    buffer_store_dwordx2 v[16:17], v22, s[20:23], s5 offen
    s_branch Ls_20_done
Ls_20_slow:
    buffer_store_dwordx2 v[16:17], v22, s[20:23], s5 offen sc1
Ls_20_done:
    s_mov_b64 exec, -1
Lq_18_e:
    v_lshlrev_b32 v4, 16, v28
    v_and_b32 v5, 0xffff0000, v28
    v_lshlrev_b32 v6, 16, v29
    v_and_b32 v7, 0xffff0000, v29
    s_mov_b32 s75, 24
    v_lshlrev_b32 v39, 4, v0
    s_lshl_b32 s5, s96, 13
    s_add_u32 s5, s5, 0xf0000
    s_lshr_b32 s3, s97, 2
    s_lshl_b32 s3, s3, 10
    s_add_u32 s5, s5, s3
    s_mov_b32 s4, 0x3db8aa3b
    v_and_b32 v35, 1, v1
    v_lshlrev_b32 v35, 6, v35
    v_lshrrev_b32 v34, 2, v2
    v_lshl_add_u32 v35, v34, 4, v35
    v_lshrrev_b32 v34, 1, v1
    v_lshl_add_u32 v35, v34, 3, v35
    v_and_b32 v34, 3, v2
    v_lshl_add_u32 v35, v34, 1, v35
    v_add_u32 v35, s77, v35
    v_lshlrev_b32 v26, 6, v2
    v_lshl_add_u32 v26, v1, 4, v26
    v_add_u32 v26, s77, v26
    v_mov_b32 v28, 0
    v_mov_b32 v29, 0
    v_mov_b32 v30, 0
    v_mov_b32 v31, 0
    s_barrier
    buffer_load_dwordx4 v[16:19], v39, s[20:23], s5 offen offset:0 sc1
Lg_21:
    s_waitcnt vmcnt(0)
    v_max3_u32 v20, v16, v17, v18
    v_max_u32 v20, v20, v19
    v_cmp_eq_u32 vcc, -1, v20
    s_cbranch_vccz Lg_21_ok
    s_sub_u32 s101, s101, 1
    s_cbranch_scc1 Lg_21_to
    s_mov_b64 exec, vcc
    buffer_load_dwordx4 v[16:19], v39, s[20:23], s5 offen offset:0 sc1
    s_mov_b64 exec, -1
    s_branch Lg_21
Lg_21_to:
    s_mov_b32 s101, 0
Lg_21_ok:
    v_mfma_f32_16x16x32_bf16 v[104:107], v[16:19], a[0:3], 0
    v_mov_b32_dpp v20, v16 row_ror:8 row_mask:0xf bank_mask:0xf
    v_mfma_f32_16x16x32_bf16 v[108:111], v[16:19], a[4:7], 0
    v_mov_b32_dpp v21, v17 row_ror:8 row_mask:0xf bank_mask:0xf
    v_mfma_f32_16x16x32_bf16 v[112:115], v[16:19], a[8:11], 0
    v_mov_b32_dpp v22, v18 row_ror:8 row_mask:0xf bank_mask:0xf
    v_mfma_f32_16x16x32_bf16 v[116:119], v[16:19], a[12:15], 0
    v_mov_b32_dpp v23, v19 row_ror:8 row_mask:0xf bank_mask:0xf
    v_mfma_f32_16x16x32_bf16 v[120:123], v[16:19], a[48:51], 0
    v_mfma_f32_16x16x32_bf16 v[124:127], v[16:19], a[52:55], 0
    v_mfma_f32_16x16x32_bf16 v[128:131], v[16:19], a[56:59], 0
    v_mfma_f32_16x16x32_bf16 v[132:135], v[16:19], a[60:63], 0
    v_mfma_f32_16x16x32_bf16 v[104:107], v[20:23], a[16:19], v[104:107]
    v_mfma_f32_16x16x32_bf16 v[108:111], v[20:23], a[20:23], v[108:111]
    v_mfma_f32_16x16x32_bf16 v[112:115], v[20:23], a[24:27], v[112:115]
    v_mfma_f32_16x16x32_bf16 v[116:119], v[20:23], a[28:31], v[116:119]
    v_mfma_f32_16x16x32_bf16 v[120:123], v[20:23], a[32:35], v[120:123]
    v_mfma_f32_16x16x32_bf16 v[124:127], v[20:23], a[36:39], v[124:127]
    v_mfma_f32_16x16x32_bf16 v[128:131], v[20:23], a[40:43], v[128:131]
    v_mfma_f32_16x16x32_bf16 v[132:135], v[20:23], a[44:47], v[132:135]
    s_nop 1
    v_add_f32 v24, v104, v109
    s_nop 0
    v_add_f32 v25, v114, v119
    v_add_f32 v24, v24, v25
    s_mov_b32 exec_lo, 0
    v_add_f32 v24, v120, v125
    v_add_f32 v25, v130, v135
    v_add_f32 v24, v24, v25
    s_mov_b32 exec_lo, -1
    s_nop 0
    v_max_f32_dpp v32, v24, v24 row_ror:8 row_mask:0xf bank_mask:0xf
    s_nop 1
    v_max_f32_dpp v32, v32, v32 row_ror:4 row_mask:0xf bank_mask:0xf
    s_nop 1
    v_max_f32_dpp v32, v32, v32 row_ror:2 row_mask:0xf bank_mask:0xf
    s_nop 1
    v_max_f32_dpp v32, v32, v32 row_ror:1 row_mask:0xf bank_mask:0xf
    v_mov_b32 v33, v32
    s_nop 1
    v_permlane32_swap_b32 v32, v33
    v_max_f32 v32, v32, v33
    v_mul_f32 v32, s4, v32
    v_fma_f32 v24, v24, s4, -v32
    v_exp_f32 v24, v24
    s_nop 0
    v_cvt_pk_bf16_f32 v25, v24, v24
    ds_write_b16 v35, v25 offset:3072
    s_mov_b64 exec, s[80:81]
    ds_read_b128 v[28:31], v26 offset:3072
    s_mov_b64 exec, -1
    v_add_f32_dpp v33, v24, v24 row_ror:8 row_mask:0xf bank_mask:0xf
    s_nop 1
    v_add_f32_dpp v33, v33, v33 row_ror:4 row_mask:0xf bank_mask:0xf
    s_nop 1
    v_add_f32_dpp v33, v33, v33 row_ror:2 row_mask:0xf bank_mask:0xf
    s_nop 1
    v_add_f32_dpp v33, v33, v33 row_ror:1 row_mask:0xf bank_mask:0xf
    v_mov_b32 v34, v33
    s_nop 1
    v_permlane32_swap_b32 v33, v34
    v_add_f32 v33, v33, v34
    v_readlane_b32 s3, v32, 16
    v_readlane_b32 s4, v33, 16
    s_nop 0
    v_writelane_b32 v32, s3, 1
    v_writelane_b32 v33, s4, 1
    s_waitcnt lgkmcnt(0)
    v_mfma_f32_16x16x32_bf16 v[16:19], v[40:43], v[28:31], 0
    v_mov_b32_dpp v24, v28 row_ror:2 row_mask:0xf bank_mask:0xf
    v_mov_b32_dpp v25, v29 row_ror:2 row_mask:0xf bank_mask:0xf
    v_mov_b32_dpp v26, v30 row_ror:2 row_mask:0xf bank_mask:0xf
    v_mov_b32_dpp v27, v31 row_ror:2 row_mask:0xf bank_mask:0xf
    v_mfma_f32_16x16x32_bf16 v[36:39], v[72:75], v[28:31], 0
    s_nop 0
    v_mfma_f32_16x16x32_bf16 v[16:19], v[44:47], v[24:27], v[16:19]
    v_mov_b32_dpp v20, v28 row_ror:4 row_mask:0xf bank_mask:0xf
    v_mov_b32_dpp v21, v29 row_ror:4 row_mask:0xf bank_mask:0xf
    v_mov_b32_dpp v22, v30 row_ror:4 row_mask:0xf bank_mask:0xf
    v_mov_b32_dpp v23, v31 row_ror:4 row_mask:0xf bank_mask:0xf
    v_mfma_f32_16x16x32_bf16 v[36:39], v[76:79], v[24:27], v[36:39]
    s_nop 0
    v_mfma_f32_16x16x32_bf16 v[16:19], v[48:51], v[20:23], v[16:19]
    v_mov_b32_dpp v24, v28 row_ror:6 row_mask:0xf bank_mask:0xf
    v_mov_b32_dpp v25, v29 row_ror:6 row_mask:0xf bank_mask:0xf
    v_mov_b32_dpp v26, v30 row_ror:6 row_mask:0xf bank_mask:0xf
    v_mov_b32_dpp v27, v31 row_ror:6 row_mask:0xf bank_mask:0xf
    v_mfma_f32_16x16x32_bf16 v[36:39], v[80:83], v[20:23], v[36:39]
    s_nop 0
    v_mfma_f32_16x16x32_bf16 v[16:19], v[52:55], v[24:27], v[16:19]
    v_mov_b32_dpp v20, v28 row_ror:8 row_mask:0xf bank_mask:0xf
    v_mov_b32_dpp v21, v29 row_ror:8 row_mask:0xf bank_mask:0xf
    v_mov_b32_dpp v22, v30 row_ror:8 row_mask:0xf bank_mask:0xf
    v_mov_b32_dpp v23, v31 row_ror:8 row_mask:0xf bank_mask:0xf
    v_mfma_f32_16x16x32_bf16 v[36:39], v[84:87], v[24:27], v[36:39]
    s_nop 0
    v_mfma_f32_16x16x32_bf16 v[16:19], v[56:59], v[20:23], v[16:19]
    v_mov_b32_dpp v24, v28 row_ror:10 row_mask:0xf bank_mask:0xf
    v_mov_b32_dpp v25, v29 row_ror:10 row_mask:0xf bank_mask:0xf
    v_mov_b32_dpp v26, v30 row_ror:10 row_mask:0xf bank_mask:0xf
    v_mov_b32_dpp v27, v31 row_ror:10 row_mask:0xf bank_mask:0xf
    v_mfma_f32_16x16x32_bf16 v[36:39], v[88:91], v[20:23], v[36:39]
    s_nop 0
    v_mfma_f32_16x16x32_bf16 v[16:19], v[60:63], v[24:27], v[16:19]
    v_mov_b32_dpp v20, v28 row_ror:12 row_mask:0xf bank_mask:0xf
    v_mov_b32_dpp v21, v29 row_ror:12 row_mask:0xf bank_mask:0xf
    v_mov_b32_dpp v22, v30 row_ror:12 row_mask:0xf bank_mask:0xf
    v_mov_b32_dpp v23, v31 row_ror:12 row_mask:0xf bank_mask:0xf
    v_mfma_f32_16x16x32_bf16 v[36:39], v[92:95], v[24:27], v[36:39]
    s_nop 0
    v_mfma_f32_16x16x32_bf16 v[16:19], v[64:67], v[20:23], v[16:19]
    v_mov_b32_dpp v24, v28 row_ror:14 row_mask:0xf bank_mask:0xf
    v_mov_b32_dpp v25, v29 row_ror:14 row_mask:0xf bank_mask:0xf
    v_mov_b32_dpp v26, v30 row_ror:14 row_mask:0xf bank_mask:0xf
    v_mov_b32_dpp v27, v31 row_ror:14 row_mask:0xf bank_mask:0xf
    v_mfma_f32_16x16x32_bf16 v[36:39], v[96:99], v[20:23], v[36:39]
    s_nop 0
    v_mfma_f32_16x16x32_bf16 v[16:19], v[68:71], v[24:27], v[16:19]
    v_mfma_f32_16x16x32_bf16 v[36:39], v[100:103], v[24:27], v[36:39]
    s_branch L_loop
L_last:
    s_and_b32 s7, s97, 7
    s_cmp_lg_u32 s7, s96
    s_cbranch_scc1 L_fin
    s_cmp_lg_u32 s7, s98
    s_cbranch_scc1 L_fin
    s_cmp_eq_u32 s7, 7
    s_cbranch_scc1 L_fin
    s_lshr_b32 s6, s97, 3
    s_mul_i32 s6, s6, 1792
    v_lshrrev_b32 v24, 2, v2
    v_lshlrev_b32 v24, 5, v24
    v_and_b32 v25, 1, v2
    v_lshl_add_u32 v24, v25, 4, v24
    v_and_b32 v25, 1, v1
    v_lshl_add_u32 v24, v25, 3, v24
    v_bfe_u32 v25, v2, 1, 1
    v_mul_u32_u24 v25, 896, v25
    v_add_u32 v24, v24, v25
    s_lshl_b32 s3, s98, 7
    v_add_u32 v24, s3, v24
    v_mul_u32_u24 v23, 3584, v1
    v_lshrrev_b32 v25, 2, v2
    v_lshl_add_u32 v23, v25, 7, v23
    v_and_b32 v25, 3, v2
    v_lshl_add_u32 v23, v25, 4, v23
    s_lshr_b32 s3, s97, 4
    s_mul_i32 s10, s3, 28672
    s_add_u32 s10, s10, s99
    s_bfe_u32 s3, s97, 0x10003
    s_lshl_b32 s3, s3, 6
    s_add_u32 s10, s10, s3
    s_lshl_b32 s3, s98, 9
    s_add_u32 s10, s10, s3
    s_add_u32 s10, s10, 0x50000
    s_add_u32 s11, s10, 14336
    buffer_load_dwordx4 v[104:107], v23, s[20:23], s10 offen offset:0 sc1
    buffer_load_dwordx4 v[108:111], v23, s[20:23], s11 offen offset:0 sc1
Lg_22:
    s_waitcnt vmcnt(0)
    v_max3_u32 v25, v104, v105, v106
    v_max3_u32 v25, v25, v107, v108
    v_max3_u32 v25, v25, v109, v110
    v_max_u32 v25, v25, v111
    v_cmp_eq_u32 vcc, -1, v25
    s_cbranch_vccz Lg_22_ok
    s_sub_u32 s101, s101, 1
    s_cbranch_scc1 Lg_22_to
    s_mov_b64 exec, vcc
    buffer_load_dwordx4 v[104:107], v23, s[20:23], s10 offen offset:0 sc1
    buffer_load_dwordx4 v[108:111], v23, s[20:23], s11 offen offset:0 sc1
    s_mov_b64 exec, -1
    s_branch Lg_22
Lg_22_to:
    s_mov_b32 s101, 0
Lg_22_ok:
    v_mfma_f32_16x16x32_bf16 v[16:19], v[12:15], v[104:107], v[4:7]
    v_mfma_f32_16x16x32_bf16 v[16:19], v[12:15], v[108:111], v[16:19]
    s_nop 7
    v_cvt_pk_bf16_f32 v28, v16, v17
    v_cvt_pk_bf16_f32 v29, v18, v19
    s_mov_b32 exec_hi, 0
    buffer_store_dwordx2 v[28:29], v24, s[48:51], s6 offen
    s_mov_b64 exec, -1
    s_cmp_lg_u32 s2, 0
    s_cbranch_scc1 L_fin
    v_mov_b32 v16, s73
    v_mov_b32 v17, 0x120000
    s_mov_b64 exec, 1
    buffer_store_dword v16, v17, s[20:23], 0 offen
    s_mov_b64 exec, -1
L_fin:
L_end:
s_endpgm
.section .rodata,"a"
.p2align 6
.amdhsa_kernel interleave_layers__sliding_block_cached__glu_gated_glu__decode_kernel
  .amdhsa_next_free_vgpr 256
  .amdhsa_next_free_sgpr 102
  .amdhsa_accum_offset 136
  .amdhsa_group_segment_fixed_size 0
  .amdhsa_kernarg_size 96
  .amdhsa_user_sgpr_count 2
  .amdhsa_user_sgpr_kernarg_segment_ptr 1
  .amdhsa_system_sgpr_workgroup_id_x 1
.end_amdhsa_kernel
```
